```python
import torch

def _softmax(x, axis=-1):
    return torch.softmax(x, dim=axis)
def _gelu(x):
    return torch.nn.functional.gelu(x, approximate="tanh")
def _silu(x):
    return torch.nn.functional.silu(x)
def _sigmoid(x):
    return torch.sigmoid(x)
def _layernorm(x, axis=-1, eps=1e-5):
    m = x.mean(dim=axis, keepdim=True)
    v = x.var(dim=axis, keepdim=True, unbiased=False)
    return (x - m) / torch.sqrt(v + eps)
def _scatter_add(tgt, idx, src, axis=0):
    return tgt.clone().index_add_(axis, idx, src)
def _segment_sum(src, seg, n):
    out = torch.zeros((n,) + src.shape[1:], dtype=src.dtype)
    return out.index_add_(0, seg, src)
def _pad(x, pw):
    flat = tuple(v for pair in reversed(pw) for v in pair)
    return torch.nn.functional.pad(x, flat)

kernel_name = 'sequential_preLN__mha_block_cached__dense_activation_relu__decode'

def setup_inputs():

    _w = (lambda a: (lambda t: t.to(torch.bfloat16) if t.is_floating_point() else t)(torch.as_tensor(a)))
    def _A_setup():
        B, Sq, D = 1, 1, 640
        H, Sk, Dh = 32, 32768, 192
        return {
            "x": _w((lambda *s: torch.randn(*s, dtype=torch.bfloat16) * 0.05)(B, Sq, D)),
            "k_cache": _w((lambda *s: torch.randn(*s, dtype=torch.bfloat16) * 3.2)(B, H, Sk, Dh)),
            "v_cache": _w((lambda *s: torch.randn(*s, dtype=torch.bfloat16) * 0.4)(B, H, Sk, Dh)),
            "wq": _w((lambda *s: torch.randn(*s, dtype=torch.bfloat16) * 3.2)(D, H * Dh) * (D ** -0.5)),
            "wo": _w((lambda *s: torch.randn(*s, dtype=torch.bfloat16) * 0.4)(H * Dh, D) * ((H * Dh) ** -0.5)),
        }
    _A_in = _A_setup()

    def _B_setup():
        B, S, D, Dff = 1, 1, 640, 1536
        return {
            "x": _w((lambda *s: torch.randn(*s, dtype=torch.bfloat16) * 0.05)(B, S, D)),
            "w1": _w((lambda *s: torch.randn(*s, dtype=torch.bfloat16) * 0.05)(D, Dff)),
            "w2": _w((lambda *s: torch.randn(*s, dtype=torch.bfloat16) * 0.05)(Dff, D)),
        }
    _B_in = _B_setup()

    return {
        "A_x": _A_in["x"],
        "A_k_cache": _A_in["k_cache"],
        "A_v_cache": _A_in["v_cache"],
        "A_wq": _A_in["wq"],
        "A_wo": _A_in["wo"],
        "B_x": _B_in["x"],
        "B_w1": _B_in["w1"],
        "B_w2": _B_in["w2"],
    }

def reference(A_x, A_k_cache, A_v_cache, A_wq, A_wo, B_x, B_w1, B_w2):
    def _A_ref(x, k_cache, v_cache, wq, wo):
        B, Sq, D = x.shape
        H, Dh = 32, 192
        q = (lambda x, *d: x.permute(*d))((x @ wq).reshape(B, Sq, H, Dh), 0, 2, 1, 3)
        scores = torch.einsum("bhqd,bhkd->bhqk", q, k_cache) * (Dh ** -0.5)
        p = _softmax(scores, axis=-1)
        o = torch.einsum("bhqk,bhkd->bhqd", p, v_cache)
        return (lambda x, *d: x.permute(*d))(o, 0, 2, 1, 3).reshape(B, Sq, H * Dh) @ wo

    def _B_ref(x, w1, w2):
        h = torch.einsum("bsd,df->bsf", x, w1)
        zero = torch.zeros_like(h)
        h = torch.maximum(h, zero)
        return torch.einsum("bsf,fd->bsd", h, w2)

    x = A_x
    h = x + _A_ref(_layernorm(x, axis=-1), A_k_cache, A_v_cache, A_wq, A_wo)
    h2 = h + _B_ref(_layernorm(h, axis=-1), B_w1, B_w2)
    return h2
```

```asm
; @launch grid=(256,1,1) block=(256,1,1) lds=160768
.amdgcn_target "amdgcn-amd-amdhsa--gfx950"
.text
.globl sequential_preLN__mha_block_cached__dense_activation_relu__decode_kernel
.p2align 8
.type sequential_preLN__mha_block_cached__dense_activation_relu__decode_kernel,@function
sequential_preLN__mha_block_cached__dense_activation_relu__decode_kernel:
  s_cmp_ge_u32 s2, 256
  s_cbranch_scc1 L_end
  s_memrealtime s[26:27]
  s_load_dwordx16 s[4:19], s[0:1], 0
  s_load_dwordx4 s[20:23], s[0:1], 64
  s_load_dwordx2 s[24:25], s[0:1], 80
  v_lshrrev_b32 v6, 6, v0
  v_and_b32 v1, 63, v0
  v_readfirstlane_b32 s64, v6
  v_lshlrev_b32 v2, 4, v1
  v_lshrrev_b32 v5, 4, v1
  s_and_b32 s66, s2, 7
  s_lshr_b32 s67, s2, 3
  s_mul_i32 s71, s66, 0
  s_add_u32 s65, s67, s71
  s_and_b32 s65, s65, 31
  s_lshl_b32 s68, s65, 3
  s_add_u32 s68, s68, s66
  s_mul_i32 s70, s66, 12
  s_add_u32 s70, s70, s67
  s_sub_u32 s70, s70, 20
  s_mul_i32 s71, s64, 24576
  s_add_u32 s75, s71, 62464
  s_add_u32 s78, s71, 74752
  s_add_u32 s76, s71, 66560
  s_add_u32 s79, s71, 78848
  s_add_u32 s77, s71, 70656
  s_add_u32 s80, s71, 82944
  v_and_b32 v23, 15, v1
  v_mul_u32_u24 v6, 384, v23
  v_lshl_add_u32 v6, v5, 4, v6
  v_add_u32 v3, s75, v6
  v_lshlrev_b32 v7, 4, v23
  v_and_b32 v7, 0x60, v7
  v_xor_b32 v200, v3, v7
  v_xor_b32 v201, 64, v200
  v_lshrrev_b32 v169, 2, v1
  v_and_b32 v170, 3, v1
  v_lshlrev_b32 v170, 3, v170
  v_mul_u32_u24 v6, 384, v169
  v_add_u32 v6, v6, v170
  v_add_u32 v4, s75, v6
  v_lshlrev_b32 v7, 4, v169
  v_and_b32 v7, 0x60, v7
  v_xor_b32 v204, v4, v7
  v_xor_b32 v205, 32, v204
  v_xor_b32 v206, 64, v204
  v_xor_b32 v207, 96, v204
  s_lshl_b32 s71, s64, 6
  s_add_u32 s71, s71, 13312
  v_mul_u32_u24 v171, 192, v169
  v_add3_u32 v171, v171, v170, s71
  s_mul_i32 s91, s65, 683
  s_mov_b32 s3, s64
  s_lshl_b32 s90, s66, 2
  s_add_u32 s90, s90, s3
  s_mov_b32 s84, 0
  s_mov_b32 s85, 28
  s_lshl_b32 s81, s84, 5
  s_add_u32 s81, s81, s90
  s_add_u32 s81, s81, s91
  s_and_b32 s81, s81, 1023
  s_mul_i32 s81, s81, 12288
  s_add_u32 s84, s84, 1
  s_sub_u32 s85, s85, 1
  v_add_u32 v6, 0, v1
  v_mul_u32_u24 v6, 2731, v6
  v_lshrrev_b32 v6, 16, v6
  v_lshlrev_b32 v7, 4, v6
  v_and_b32 v7, 0x60, v7
  v_xor_b32 v196, v7, v2
  v_add_u32 v6, 0, v1
  v_mul_u32_u24 v6, 5462, v6
  v_lshrrev_b32 v6, 16, v6
  v_mul_u32_u24 v6, 12096, v6
  v_add_u32 v164, v6, v2
  v_add_u32 v6, 64, v1
  v_mul_u32_u24 v6, 2731, v6
  v_lshrrev_b32 v6, 16, v6
  v_lshlrev_b32 v7, 4, v6
  v_and_b32 v7, 0x60, v7
  v_xor_b32 v197, v7, v2
  v_add_u32 v6, 64, v1
  v_mul_u32_u24 v6, 5462, v6
  v_lshrrev_b32 v6, 16, v6
  v_mul_u32_u24 v6, 12096, v6
  v_add_u32 v165, v6, v2
  v_add_u32 v6, 128, v1
  v_mul_u32_u24 v6, 2731, v6
  v_lshrrev_b32 v6, 16, v6
  v_lshlrev_b32 v7, 4, v6
  v_and_b32 v7, 0x60, v7
  v_xor_b32 v198, v7, v2
  v_add_u32 v6, 128, v1
  v_mul_u32_u24 v6, 5462, v6
  v_lshrrev_b32 v6, 16, v6
  v_mul_u32_u24 v6, 12096, v6
  v_add_u32 v166, v6, v2
  v_lshlrev_b32 v167, 2, v1
  s_lshl_b32 s68, s68, 10
  s_mul_i32 s72, s65, 12582912
  s_and_b32 s74, s66, 3
  s_and_b32 s73, s67, 1
  s_lshl1_add_u32 s87, s74, s73
  s_and_b32 s86, s67, 30
  s_lshr_b32 s71, s66, 2
  s_add_u32 s86, s86, s71
  s_lshl1_add_u32 s73, s86, s73
  s_mul_i32 s73, s73, 192
  s_mul_i32 s71, s74, 1966080
  s_add_u32 s73, s71, s73
  s_mul_i32 s74, s74, 320
  s_waitcnt lgkmcnt(0)
  s_mov_b64 s[14:15], s[86:87]
  s_mov_b32 s44, s4
  s_and_b32 s45, s5, 0xffff
  s_mov_b32 s46, 1280
  s_mov_b32 s47, 0x20000
  s_mov_b32 s36, s24
  s_and_b32 s37, s25, 0xffff
  s_mov_b32 s38, 2097152
  s_mov_b32 s39, 0x20000
  s_cmp_eq_u32 s64, 3
  s_cbranch_scc1 L_comm
  s_add_u32 s40, s10, s73
  s_addc_u32 s41, s11, 0
  s_and_b32 s41, s41, 0xffff
  s_mov_b32 s42, 1953984
  s_mov_b32 s43, 0x20000
  v_lshlrev_b32 v168, 3, v1
  buffer_load_dword v172, v167, s[44:47], 0 offen offset:0
  buffer_load_dword v173, v167, s[44:47], 0 offen offset:256
  buffer_load_dword v174, v167, s[44:47], 0 offen offset:512
  buffer_load_dword v175, v167, s[44:47], 0 offen offset:768
  buffer_load_dword v176, v167, s[44:47], 0 offen offset:1024
  buffer_load_dwordx2 v[178:179], v168, s[44:47], s74 offen
  s_mov_b32 s73, s64
  s_mul_i32 s71, s73, 3072
  s_add_u32 m0, s71, 13312
  s_mul_i32 s71, s73, 196608
  buffer_load_dwordx4 v164, s[40:43], s71 offen offset:0 nt lds
  buffer_load_dwordx4 v165, s[40:43], s71 offen offset:1024 nt lds
  buffer_load_dwordx4 v166, s[40:43], s71 offen offset:2048 nt lds
  s_add_u32 s73, s73, 3
  s_mul_i32 s71, s73, 3072
  s_add_u32 m0, s71, 13312
  s_mul_i32 s71, s73, 196608
  buffer_load_dwordx4 v164, s[40:43], s71 offen offset:0 nt lds
  buffer_load_dwordx4 v165, s[40:43], s71 offen offset:1024 nt lds
  buffer_load_dwordx4 v166, s[40:43], s71 offen offset:2048 nt lds
  s_add_u32 s73, s73, 3
  s_mul_i32 s71, s73, 3072
  s_add_u32 m0, s71, 13312
  s_mul_i32 s71, s73, 196608
  buffer_load_dwordx4 v164, s[40:43], s71 offen offset:0 nt lds
  buffer_load_dwordx4 v165, s[40:43], s71 offen offset:1024 nt lds
  buffer_load_dwordx4 v166, s[40:43], s71 offen offset:2048 nt lds
  s_add_u32 s73, s73, 3
  s_cmp_lg_u32 s64, 0
  s_cbranch_scc1 L_wq_done
  s_mul_i32 s71, s73, 3072
  s_add_u32 m0, s71, 13312
  s_mul_i32 s71, s73, 196608
  buffer_load_dwordx4 v164, s[40:43], s71 offen offset:0 nt lds
  buffer_load_dwordx4 v165, s[40:43], s71 offen offset:1024 nt lds
  buffer_load_dwordx4 v166, s[40:43], s71 offen offset:2048 nt lds
L_wq_done:
  s_add_u32 s28, s6, s72
  s_addc_u32 s29, s7, 0
  s_and_b32 s29, s29, 0xffff
  s_mov_b32 s30, 12582912
  s_mov_b32 s31, 0x20000
  s_mov_b32 m0, s75
  s_mov_b32 s71, s81
  buffer_load_dwordx4 v196, s[28:31], s71 offen offset:0 nt lds
  buffer_load_dwordx4 v197, s[28:31], s71 offen offset:1024 nt lds
  buffer_load_dwordx4 v198, s[28:31], s71 offen offset:2048 nt lds
  buffer_load_dwordx4 v196, s[28:31], s71 offen offset:3072 nt lds
  s_add_u32 s32, s8, s72
  s_addc_u32 s33, s9, 0
  s_and_b32 s33, s33, 0xffff
  s_mov_b32 s34, 12582912
  s_mov_b32 s35, 0x20000
  v_cmp_eq_u32 s[86:87], 1, v5
  s_lshl_b32 s71, s64, 9
  s_add_u32 s71, s71, 10752
  v_add_u32 v167, s71, v168
  v_lshl_add_u32 v168, v5, 3, s71
  s_waitcnt vmcnt(13)
  v_lshlrev_b32 v36, 16, v172
  v_and_b32 v37, 0xffff0000, v172
  v_lshlrev_b32 v38, 16, v173
  v_and_b32 v39, 0xffff0000, v173
  v_lshlrev_b32 v40, 16, v174
  v_and_b32 v41, 0xffff0000, v174
  v_lshlrev_b32 v42, 16, v175
  v_and_b32 v43, 0xffff0000, v175
  v_lshlrev_b32 v44, 16, v176
  v_and_b32 v45, 0xffff0000, v176
  v_pk_add_f32 v[24:25], v[36:37], v[38:39]
  v_pk_add_f32 v[26:27], v[40:41], v[42:43]
  v_pk_add_f32 v[24:25], v[24:25], v[26:27]
  v_pk_add_f32 v[24:25], v[24:25], v[44:45]
  v_add_f32 v6, v24, v25
  s_nop 1
  v_add_f32_dpp v6, v6, v6 row_ror:8 row_mask:0xf bank_mask:0xf
  s_nop 1
  v_add_f32_dpp v6, v6, v6 row_ror:4 row_mask:0xf bank_mask:0xf
  s_nop 1
  v_add_f32_dpp v6, v6, v6 row_ror:2 row_mask:0xf bank_mask:0xf
  s_nop 1
  v_add_f32_dpp v6, v6, v6 row_ror:1 row_mask:0xf bank_mask:0xf
  s_nop 1
  v_mov_b32 v9, v6
  s_nop 1
  v_permlane16_swap_b32 v6, v9
  v_add_f32 v6, v6, v9
  v_mov_b32 v9, v6
  s_nop 1
  v_permlane32_swap_b32 v6, v9
  v_add_f32 v6, v6, v9
  v_mul_f32 v6, 0x3acccccd, v6
  v_sub_f32 v36, v36, v6
  v_sub_f32 v37, v37, v6
  v_sub_f32 v38, v38, v6
  v_sub_f32 v39, v39, v6
  v_sub_f32 v40, v40, v6
  v_sub_f32 v41, v41, v6
  v_sub_f32 v42, v42, v6
  v_sub_f32 v43, v43, v6
  v_sub_f32 v44, v44, v6
  v_sub_f32 v45, v45, v6
  v_pk_mul_f32 v[24:25], v[36:37], v[36:37]
  v_pk_fma_f32 v[24:25], v[38:39], v[38:39], v[24:25]
  v_pk_fma_f32 v[24:25], v[40:41], v[40:41], v[24:25]
  v_pk_fma_f32 v[24:25], v[42:43], v[42:43], v[24:25]
  v_pk_fma_f32 v[24:25], v[44:45], v[44:45], v[24:25]
  v_add_f32 v7, v24, v25
  s_nop 1
  v_add_f32_dpp v7, v7, v7 row_ror:8 row_mask:0xf bank_mask:0xf
  s_nop 1
  v_add_f32_dpp v7, v7, v7 row_ror:4 row_mask:0xf bank_mask:0xf
  s_nop 1
  v_add_f32_dpp v7, v7, v7 row_ror:2 row_mask:0xf bank_mask:0xf
  s_nop 1
  v_add_f32_dpp v7, v7, v7 row_ror:1 row_mask:0xf bank_mask:0xf
  s_nop 1
  v_mov_b32 v9, v7
  s_nop 1
  v_permlane16_swap_b32 v7, v9
  v_add_f32 v7, v7, v9
  v_mov_b32 v9, v7
  s_nop 1
  v_permlane32_swap_b32 v7, v9
  v_add_f32 v7, v7, v9
  v_mul_f32 v7, 0x3acccccd, v7
  v_cvt_pk_bf16_f32 v9, v6, v6
  v_and_b32 v6, 0xffff0000, v9
  v_cvt_pk_bf16_f32 v9, v7, v7
  v_and_b32 v7, 0xffff0000, v9
  v_add_f32 v7, 0x3727c5ac, v7
  v_cvt_pk_bf16_f32 v9, v7, v7
  v_and_b32 v7, 0xffff0000, v9
  v_sqrt_f32 v7, v7
  s_nop 0
  v_cvt_pk_bf16_f32 v9, v7, v7
  v_and_b32 v7, 0xffff0000, v9
  v_rcp_f32 v8, v7
  s_nop 0
  v_lshlrev_b32 v10, 16, v178
  v_and_b32 v11, 0xffff0000, v178
  v_sub_f32 v10, v10, v6
  v_sub_f32 v11, v11, v6
  v_cvt_pk_bf16_f32 v178, v10, v11
  v_lshlrev_b32 v10, 16, v178
  v_and_b32 v11, 0xffff0000, v178
  v_mul_f32 v12, v10, v8
  v_mul_f32 v13, v11, v8
  v_fma_f32 v10, -v12, v7, v10
  v_fma_f32 v11, -v13, v7, v11
  v_fma_f32 v12, v10, v8, v12
  v_fma_f32 v13, v11, v8, v13
  v_cvt_pk_bf16_f32 v178, v12, v13
  v_lshlrev_b32 v10, 16, v179
  v_and_b32 v11, 0xffff0000, v179
  v_sub_f32 v10, v10, v6
  v_sub_f32 v11, v11, v6
  v_cvt_pk_bf16_f32 v179, v10, v11
  v_lshlrev_b32 v10, 16, v179
  v_and_b32 v11, 0xffff0000, v179
  v_mul_f32 v12, v10, v8
  v_mul_f32 v13, v11, v8
  v_fma_f32 v10, -v12, v7, v10
  v_fma_f32 v11, -v13, v7, v11
  v_fma_f32 v12, v10, v8, v12
  v_fma_f32 v13, v11, v8, v13
  v_cvt_pk_bf16_f32 v179, v12, v13
  ds_write_b64 v167, v[178:179]
  s_waitcnt lgkmcnt(0)
  ds_read_b64 v[116:117], v168 offset:0
  ds_read_b64 v[118:119], v168 offset:32
  ds_read_b64 v[120:121], v168 offset:64
  ds_read_b64 v[122:123], v168 offset:96
  ds_read_b64 v[124:125], v168 offset:128
  ds_read_b64 v[126:127], v168 offset:160
  ds_read_b64 v[128:129], v168 offset:192
  ds_read_b64 v[130:131], v168 offset:224
  ds_read_b64 v[132:133], v168 offset:256
  ds_read_b64 v[134:135], v168 offset:288
  s_lshl3_add_u32 s73, s14, s15
  s_lshl2_add_u32 s73, s73, s64
  s_lshl_b32 s73, s73, 8
  s_add_u32 s73, s73, 1572864
  v_lshlrev_b32 v6, 3, v1
  v_mov_b32 v7, 0
  s_waitcnt lgkmcnt(0)
  s_waitcnt vmcnt(4)
  s_barrier
  ds_read_b32 v9, v7 offset:384
  ds_read_b64_tr_b16 v[68:69], v171 offset:0
  ds_read_b64_tr_b16 v[70:71], v171 offset:3072
  ds_read_b64_tr_b16 v[72:73], v171 offset:32
  ds_read_b64_tr_b16 v[74:75], v171 offset:3104
  ds_read_b64_tr_b16 v[76:77], v171 offset:6144
  ds_read_b64_tr_b16 v[78:79], v171 offset:9216
  ds_read_b64_tr_b16 v[80:81], v171 offset:6176
  ds_read_b64_tr_b16 v[82:83], v171 offset:9248
  ds_read_b64_tr_b16 v[84:85], v171 offset:12288
  ds_read_b64_tr_b16 v[86:87], v171 offset:15360
  ds_read_b64_tr_b16 v[88:89], v171 offset:12320
  ds_read_b64_tr_b16 v[90:91], v171 offset:15392
  ds_read_b64_tr_b16 v[92:93], v171 offset:18432
  ds_read_b64_tr_b16 v[94:95], v171 offset:21504
  s_waitcnt lgkmcnt(12)
  v_mfma_f32_16x16x32_bf16 v[24:27], v[116:119], v[68:71], 0
  ds_read_b64_tr_b16 v[96:97], v171 offset:18464
  ds_read_b64_tr_b16 v[98:99], v171 offset:21536
  s_waitcnt lgkmcnt(12)
  v_mfma_f32_16x16x32_bf16 v[28:31], v[116:119], v[72:75], 0
  ds_read_b64_tr_b16 v[100:101], v171 offset:24576
  ds_read_b64_tr_b16 v[102:103], v171 offset:27648
  s_waitcnt lgkmcnt(12)
  v_mfma_f32_16x16x32_bf16 v[24:27], v[120:123], v[76:79], v[24:27]
  ds_read_b64_tr_b16 v[104:105], v171 offset:24608
  ds_read_b64_tr_b16 v[106:107], v171 offset:27680
  s_waitcnt lgkmcnt(12)
  v_mfma_f32_16x16x32_bf16 v[28:31], v[120:123], v[80:83], v[28:31]
  s_waitcnt lgkmcnt(10)
  v_mfma_f32_16x16x32_bf16 v[24:27], v[124:127], v[84:87], v[24:27]
  s_waitcnt lgkmcnt(8)
  v_mfma_f32_16x16x32_bf16 v[28:31], v[124:127], v[88:91], v[28:31]
  s_waitcnt lgkmcnt(6)
  v_mfma_f32_16x16x32_bf16 v[24:27], v[128:131], v[92:95], v[24:27]
  s_waitcnt lgkmcnt(4)
  v_mfma_f32_16x16x32_bf16 v[28:31], v[128:131], v[96:99], v[28:31]
  s_waitcnt lgkmcnt(2)
  v_mfma_f32_16x16x32_bf16 v[24:27], v[132:135], v[100:103], v[24:27]
  s_waitcnt lgkmcnt(0)
  v_mfma_f32_16x16x32_bf16 v[28:31], v[132:135], v[104:107], v[28:31]
  s_bfm_b64 exec, 32, 0
  s_nop 6
  v_cndmask_b32 v8, v24, v28, s[86:87]
  buffer_store_dwordx2 v[8:9], v6, s[36:39], s73 offen sc1
  s_mov_b64 exec, -1
  s_mov_b32 m0, s76
  s_add_u32 s71, s81, 4096
  buffer_load_dwordx4 v197, s[28:31], s71 offen offset:0 nt lds
  buffer_load_dwordx4 v198, s[28:31], s71 offen offset:1024 nt lds
  buffer_load_dwordx4 v196, s[28:31], s71 offen offset:2048 nt lds
  buffer_load_dwordx4 v197, s[28:31], s71 offen offset:3072 nt lds
  s_barrier
  s_mov_b32 s92, 0x1f1e1c
  s_mov_b32 s93, 0x0
  s_mov_b32 s94, 0x10102
  s_mov_b32 s95, 0x0
  s_lshl_b32 s71, s65, 2
  s_add_u32 s71, s71, s3
  s_lshl_b32 s71, s71, 8
  s_add_u32 s71, s71, 851968
  s_mov_b32 s97, s71
  s_cmp_eq_u32 s64, 3
  s_cselect_b32 s98, 8, 63
  s_mov_b32 s88, 0x3fb8aa3b
  s_mov_b32 s89, 0x3d93cd3a
  s_mul_i32 s71, s64, 320
  v_lshlrev_b32 v7, 3, v1
  buffer_load_dwordx2 v[20:21], v7, s[44:47], s71 offen
  v_mov_b32 v16, 0xff800000
  v_mov_b32 v17, 0
  v_mov_b32 v116, 0
  v_mov_b32 v117, 0
  v_mov_b32 v118, 0
  v_mov_b32 v119, 0
  v_mov_b32 v120, 0
  v_mov_b32 v121, 0
  v_mov_b32 v122, 0
  v_mov_b32 v123, 0
  v_mov_b32 v124, 0
  v_mov_b32 v125, 0
  v_mov_b32 v126, 0
  v_mov_b32 v127, 0
  v_mov_b32 v128, 0
  v_mov_b32 v129, 0
  v_mov_b32 v130, 0
  v_mov_b32 v131, 0
  v_mov_b32 v132, 0
  v_mov_b32 v133, 0
  v_mov_b32 v134, 0
  v_mov_b32 v135, 0
  v_mov_b32 v136, 0
  v_mov_b32 v137, 0
  v_mov_b32 v138, 0
  v_mov_b32 v139, 0
  v_mov_b32 v140, 0
  v_mov_b32 v141, 0
  v_mov_b32 v142, 0
  v_mov_b32 v143, 0
  v_mov_b32 v144, 0
  v_mov_b32 v145, 0
  v_mov_b32 v146, 0
  v_mov_b32 v147, 0
  v_mov_b32 v148, 0
  v_mov_b32 v149, 0
  v_mov_b32 v150, 0
  v_mov_b32 v151, 0
  v_mov_b32 v152, 0
  v_mov_b32 v153, 0
  v_mov_b32 v154, 0
  v_mov_b32 v155, 0
  v_mov_b32 v156, 0
  v_mov_b32 v157, 0
  v_mov_b32 v158, 0
  v_mov_b32 v159, 0
  v_mov_b32 v160, 0
  v_mov_b32 v161, 0
  v_mov_b32 v162, 0
  v_mov_b32 v163, 0
  s_mov_b32 s82, 0
  s_mov_b32 m0, s77
  s_add_u32 s71, s81, 8192
  buffer_load_dwordx4 v198, s[28:31], s71 offen offset:0 nt lds
  buffer_load_dwordx4 v196, s[28:31], s71 offen offset:1024 nt lds
  buffer_load_dwordx4 v197, s[28:31], s71 offen offset:2048 nt lds
  buffer_load_dwordx4 v198, s[28:31], s71 offen offset:3072 nt lds
  s_lshl_b32 s81, s84, 5
  s_add_u32 s81, s81, s90
  s_add_u32 s81, s81, s91
  s_and_b32 s81, s81, 1023
  s_mul_i32 s81, s81, 12288
  s_add_u32 s84, s84, 1
  s_sub_u32 s85, s85, 1
  s_waitcnt vmcnt(8)
  s_mov_b32 m0, s78
  s_mov_b32 s71, s81
  buffer_load_dwordx4 v196, s[28:31], s71 offen offset:0 nt lds
  buffer_load_dwordx4 v197, s[28:31], s71 offen offset:1024 nt lds
  buffer_load_dwordx4 v198, s[28:31], s71 offen offset:2048 nt lds
  buffer_load_dwordx4 v196, s[28:31], s71 offen offset:3072 nt lds
  s_waitcnt vmcnt(8)
  s_mov_b32 m0, s79
  s_add_u32 s71, s81, 4096
  buffer_load_dwordx4 v197, s[28:31], s71 offen offset:0 nt lds
  buffer_load_dwordx4 v198, s[28:31], s71 offen offset:1024 nt lds
  buffer_load_dwordx4 v196, s[28:31], s71 offen offset:2048 nt lds
  buffer_load_dwordx4 v197, s[28:31], s71 offen offset:3072 nt lds
  s_waitcnt vmcnt(8)
  s_mov_b32 m0, s80
  s_add_u32 s71, s81, 8192
  buffer_load_dwordx4 v198, s[28:31], s71 offen offset:0 nt lds
  buffer_load_dwordx4 v196, s[28:31], s71 offen offset:1024 nt lds
  buffer_load_dwordx4 v197, s[28:31], s71 offen offset:2048 nt lds
  buffer_load_dwordx4 v198, s[28:31], s71 offen offset:3072 nt lds
  s_barrier
  s_branch L_qready
L_comm:
  s_mov_b32 s48, s22
  s_and_b32 s49, s23, 0xffff
  s_mov_b32 s50, 256
  s_mov_b32 s51, 0x20000
  v_mov_b32 v11, 0
  s_bfm_b64 exec, 1, 0
  s_cmp_ge_u32 s2, 8
  s_cbranch_scc1 L_no_nonce
  s_max_u32 s26, s26, 1
  v_mov_b32 v10, s26
  buffer_atomic_cmpswap v[10:11], v2, s[48:51], 0 offen sc1
L_no_nonce:
  s_cmp_ge_u32 s15, 4
  s_cbranch_scc1 L_no_ct
  s_lshl_b32 s71, s14, 2
  s_add_u32 s71, s71, s15
  s_lshl_b32 s71, s71, 8
  s_add_u32 s71, s71, 851968
  buffer_store_dword v11, v2, s[36:39], s71 offen sc1
L_no_ct:
  s_mov_b64 exec, -1
  v_mov_b32 v6, -1
  v_mov_b32 v7, -1
  v_mov_b32 v8, -1
  v_mov_b32 v9, -1
  s_bfm_b64 exec, 49, 0
  s_add_u32 s71, s68, 262144
  buffer_store_dwordx4 v[6:9], v2, s[36:39], s71 offen sc1
  s_cmp_ge_u32 s67, 20
  s_cbranch_scc1 L_clr_ffn
  s_bfm_b64 exec, 8, 0
  s_mul_i32 s71, s66, 2560
  s_lshl_b32 s73, s67, 7
  s_add_u32 s71, s71, s73
  s_add_u32 s71, s71, 524288
  buffer_store_dwordx4 v[6:9], v2, s[36:39], s71 offen sc1
  s_branch L_clr_ct
L_clr_ffn:
  s_mov_b64 exec, -1
  s_mul_i32 s71, s70, 2560
  s_add_u32 s71, s71, 589824
  buffer_store_dwordx4 v[6:9], v2, s[36:39], s71 offen sc1
  buffer_store_dwordx4 v[6:9], v2, s[36:39], s71 offen offset:1024 sc1
  s_bfm_b64 exec, 32, 0
  buffer_store_dwordx4 v[6:9], v2, s[36:39], s71 offen offset:2048 sc1
L_clr_ct:
L_clr_done:
  s_mov_b64 exec, -1
  s_add_u32 s28, s6, s72
  s_addc_u32 s29, s7, 0
  s_and_b32 s29, s29, 0xffff
  s_mov_b32 s30, 12582912
  s_mov_b32 s31, 0x20000
  s_mov_b32 m0, s75
  s_mov_b32 s71, s81
  buffer_load_dwordx4 v196, s[28:31], s71 offen offset:0 nt lds
  buffer_load_dwordx4 v197, s[28:31], s71 offen offset:1024 nt lds
  buffer_load_dwordx4 v198, s[28:31], s71 offen offset:2048 nt lds
  buffer_load_dwordx4 v196, s[28:31], s71 offen offset:3072 nt lds
  s_mov_b32 m0, s76
  s_add_u32 s71, s81, 4096
  buffer_load_dwordx4 v197, s[28:31], s71 offen offset:0 nt lds
  buffer_load_dwordx4 v198, s[28:31], s71 offen offset:1024 nt lds
  buffer_load_dwordx4 v196, s[28:31], s71 offen offset:2048 nt lds
  buffer_load_dwordx4 v197, s[28:31], s71 offen offset:3072 nt lds
  s_mov_b32 m0, s77
  s_add_u32 s71, s81, 8192
  buffer_load_dwordx4 v198, s[28:31], s71 offen offset:0 nt lds
  buffer_load_dwordx4 v196, s[28:31], s71 offen offset:1024 nt lds
  buffer_load_dwordx4 v197, s[28:31], s71 offen offset:2048 nt lds
  buffer_load_dwordx4 v198, s[28:31], s71 offen offset:3072 nt lds
  s_add_u32 s32, s8, s72
  s_addc_u32 s33, s9, 0
  s_and_b32 s33, s33, 0xffff
  s_mov_b32 s34, 12582912
  s_mov_b32 s35, 0x20000
  s_mov_b32 s83, 65536
  s_load_dword s26, s[22:23], 0x0
  v_mov_b32 v12, 0
  s_waitcnt lgkmcnt(0)
L_noncepoll:
  s_cmp_lg_u32 s26, 0
  s_cbranch_scc1 L_nonce_ok
  buffer_load_dword v10, v12, s[48:51], 0 offen sc1
  s_sub_u32 s83, s83, 1
  s_waitcnt vmcnt(0)
  v_readfirstlane_b32 s26, v10
  s_cmp_lg_u32 s83, 0
  s_cbranch_scc1 L_noncepoll
  s_branch L_end
L_nonce_ok:
  v_mov_b32 v10, s26
  v_mov_b32 v11, s26
  v_mov_b32 v12, 0
  ds_write_b64 v12, v[10:11] offset:384
  s_lshl_b32 s72, s65, 13
  s_add_u32 s72, s72, 1572864
  s_add_u32 s73, s72, 4096
  s_waitcnt vmcnt(12) lgkmcnt(0)
  s_barrier
  s_mov_b32 s92, 0x1f1e1c
  s_mov_b32 s93, 0x0
  s_mov_b32 s94, 0x10102
  s_mov_b32 s95, 0x0
  s_lshl_b32 s71, s65, 2
  s_add_u32 s71, s71, s3
  s_lshl_b32 s71, s71, 8
  s_add_u32 s71, s71, 851968
  s_mov_b32 s97, s71
  s_cmp_eq_u32 s64, 3
  s_cselect_b32 s98, 8, 63
  s_mov_b32 s88, 0x3fb8aa3b
  s_mov_b32 s89, 0x3d93cd3a
  s_mul_i32 s71, s64, 320
  v_lshlrev_b32 v7, 3, v1
  buffer_load_dwordx2 v[20:21], v7, s[44:47], s71 offen
  v_mov_b32 v16, 0xff800000
  v_mov_b32 v17, 0
  v_mov_b32 v116, 0
  v_mov_b32 v117, 0
  v_mov_b32 v118, 0
  v_mov_b32 v119, 0
  v_mov_b32 v120, 0
  v_mov_b32 v121, 0
  v_mov_b32 v122, 0
  v_mov_b32 v123, 0
  v_mov_b32 v124, 0
  v_mov_b32 v125, 0
  v_mov_b32 v126, 0
  v_mov_b32 v127, 0
  v_mov_b32 v128, 0
  v_mov_b32 v129, 0
  v_mov_b32 v130, 0
  v_mov_b32 v131, 0
  v_mov_b32 v132, 0
  v_mov_b32 v133, 0
  v_mov_b32 v134, 0
  v_mov_b32 v135, 0
  v_mov_b32 v136, 0
  v_mov_b32 v137, 0
  v_mov_b32 v138, 0
  v_mov_b32 v139, 0
  v_mov_b32 v140, 0
  v_mov_b32 v141, 0
  v_mov_b32 v142, 0
  v_mov_b32 v143, 0
  v_mov_b32 v144, 0
  v_mov_b32 v145, 0
  v_mov_b32 v146, 0
  v_mov_b32 v147, 0
  v_mov_b32 v148, 0
  v_mov_b32 v149, 0
  v_mov_b32 v150, 0
  v_mov_b32 v151, 0
  v_mov_b32 v152, 0
  v_mov_b32 v153, 0
  v_mov_b32 v154, 0
  v_mov_b32 v155, 0
  v_mov_b32 v156, 0
  v_mov_b32 v157, 0
  v_mov_b32 v158, 0
  v_mov_b32 v159, 0
  v_mov_b32 v160, 0
  v_mov_b32 v161, 0
  v_mov_b32 v162, 0
  v_mov_b32 v163, 0
  s_mov_b32 s82, 0
  s_barrier
  s_bfm_b64 exec, 48, 0
  s_mov_b32 s83, 65536
L_qpoll:
  buffer_load_dwordx4 v[44:47], v2, s[36:39], s72 offen offset:0 sc1
  buffer_load_dwordx4 v[48:51], v2, s[36:39], s72 offen offset:1024 sc1
  buffer_load_dwordx4 v[52:55], v2, s[36:39], s72 offen offset:2048 sc1
  buffer_load_dwordx4 v[56:59], v2, s[36:39], s72 offen offset:3072 sc1
  buffer_load_dwordx4 v[60:63], v2, s[36:39], s73 offen offset:0 sc1
  buffer_load_dwordx4 v[64:67], v2, s[36:39], s73 offen offset:1024 sc1
  buffer_load_dwordx4 v[68:71], v2, s[36:39], s73 offen offset:2048 sc1
  buffer_load_dwordx4 v[72:75], v2, s[36:39], s73 offen offset:3072 sc1
  s_waitcnt vmcnt(0)
  v_xor_b32 v6, v45, v10
  v_bitop3_b32 v6, v47, v10, v6 bitop3:0xbe
  v_bitop3_b32 v6, v49, v10, v6 bitop3:0xbe
  v_bitop3_b32 v6, v51, v10, v6 bitop3:0xbe
  v_bitop3_b32 v6, v53, v10, v6 bitop3:0xbe
  v_bitop3_b32 v6, v55, v10, v6 bitop3:0xbe
  v_bitop3_b32 v6, v57, v10, v6 bitop3:0xbe
  v_bitop3_b32 v6, v59, v10, v6 bitop3:0xbe
  v_bitop3_b32 v6, v61, v10, v6 bitop3:0xbe
  v_bitop3_b32 v6, v63, v10, v6 bitop3:0xbe
  v_bitop3_b32 v6, v65, v10, v6 bitop3:0xbe
  v_bitop3_b32 v6, v67, v10, v6 bitop3:0xbe
  v_bitop3_b32 v6, v69, v10, v6 bitop3:0xbe
  v_bitop3_b32 v6, v71, v10, v6 bitop3:0xbe
  v_bitop3_b32 v6, v73, v10, v6 bitop3:0xbe
  v_bitop3_b32 v6, v75, v10, v6 bitop3:0xbe
  v_cmp_ne_u32 vcc, 0, v6
  s_nop 0
  s_cbranch_vccz L_qgot
  s_sub_u32 s83, s83, 1
  s_cmp_lg_u32 s83, 0
  s_cbranch_scc1 L_qpoll
  s_branch L_end
L_qgot:
  v_add_f32 v44, v44, v52
  v_add_f32 v46, v46, v54
  v_add_f32 v48, v48, v56
  v_add_f32 v50, v50, v58
  v_add_f32 v44, v44, v60
  v_add_f32 v46, v46, v62
  v_add_f32 v48, v48, v64
  v_add_f32 v50, v50, v66
  v_add_f32 v44, v44, v68
  v_add_f32 v46, v46, v70
  v_add_f32 v48, v48, v72
  v_add_f32 v50, v50, v74
  v_cvt_pk_bf16_f32 v44, v44, v46
  v_cvt_pk_bf16_f32 v48, v48, v50
  v_lshlrev_b32 v6, 2, v1
  ds_write2_b32 v6, v44, v48 offset0:0 offset1:48
  s_mov_b64 exec, -1
  s_cmp_lg_u32 s66, 0
  s_cbranch_scc1 L_no_cnt
  s_mov_b32 s99, 1
  s_atomic_add s99, s[22:23], 0x80
L_no_cnt:
  s_lshl_b32 s81, s84, 5
  s_add_u32 s81, s81, s90
  s_add_u32 s81, s81, s91
  s_and_b32 s81, s81, 1023
  s_mul_i32 s81, s81, 12288
  s_add_u32 s84, s84, 1
  s_sub_u32 s85, s85, 1
  s_waitcnt lgkmcnt(0)
  s_barrier
  s_mov_b32 m0, s78
  s_mov_b32 s71, s81
  buffer_load_dwordx4 v196, s[28:31], s71 offen offset:0 nt lds
  buffer_load_dwordx4 v197, s[28:31], s71 offen offset:1024 nt lds
  buffer_load_dwordx4 v198, s[28:31], s71 offen offset:2048 nt lds
  buffer_load_dwordx4 v196, s[28:31], s71 offen offset:3072 nt lds
  s_mov_b32 m0, s79
  s_add_u32 s71, s81, 4096
  buffer_load_dwordx4 v197, s[28:31], s71 offen offset:0 nt lds
  buffer_load_dwordx4 v198, s[28:31], s71 offen offset:1024 nt lds
  buffer_load_dwordx4 v196, s[28:31], s71 offen offset:2048 nt lds
  buffer_load_dwordx4 v197, s[28:31], s71 offen offset:3072 nt lds
  s_mov_b32 m0, s80
  s_add_u32 s71, s81, 8192
  buffer_load_dwordx4 v198, s[28:31], s71 offen offset:0 nt lds
  buffer_load_dwordx4 v196, s[28:31], s71 offen offset:1024 nt lds
  buffer_load_dwordx4 v197, s[28:31], s71 offen offset:2048 nt lds
  buffer_load_dwordx4 v198, s[28:31], s71 offen offset:3072 nt lds
L_qready:
  s_cmp_ge_u32 s67, 20
  s_cbranch_scc1 L_wf1
  s_mov_b32 s52, s12
  s_and_b32 s53, s13, 0xffff
  s_mov_b32 s54, 7864320
  s_mov_b32 s55, 0x20000
  v_mul_u32_u24 v7, 1280, v169
  v_lshl_add_u32 v7, v170, 1, v7
  s_lshl_b32 s71, s66, 2
  s_add_u32 s71, s71, s64
  s_mul_i32 s71, s71, 245760
  s_lshl_b32 s72, s67, 6
  s_add_u32 s71, s71, s72
  s_mul_i32 s73, s64, 12288
  s_add_u32 m0, s73, 13312
  s_add_u32 s72, s71, 0
  buffer_load_dwordx4 v7, s[52:55], s72 offen nt lds
  s_add_u32 m0, s73, 14336
  s_add_u32 s72, s71, 20480
  buffer_load_dwordx4 v7, s[52:55], s72 offen nt lds
  s_add_u32 m0, s73, 15360
  s_add_u32 s72, s71, 40960
  buffer_load_dwordx4 v7, s[52:55], s72 offen nt lds
  s_add_u32 m0, s73, 16384
  s_add_u32 s72, s71, 61440
  buffer_load_dwordx4 v7, s[52:55], s72 offen nt lds
  s_add_u32 m0, s73, 17408
  s_add_u32 s72, s71, 81920
  buffer_load_dwordx4 v7, s[52:55], s72 offen nt lds
  s_add_u32 m0, s73, 18432
  s_add_u32 s72, s71, 102400
  buffer_load_dwordx4 v7, s[52:55], s72 offen nt lds
  s_add_u32 m0, s73, 19456
  s_add_u32 s72, s71, 122880
  buffer_load_dwordx4 v7, s[52:55], s72 offen nt lds
  s_add_u32 m0, s73, 20480
  s_add_u32 s72, s71, 143360
  buffer_load_dwordx4 v7, s[52:55], s72 offen nt lds
  s_add_u32 m0, s73, 21504
  s_add_u32 s72, s71, 163840
  buffer_load_dwordx4 v7, s[52:55], s72 offen nt lds
  s_branch L_wd2
L_wf1:
  s_mov_b32 s52, s16
  s_and_b32 s53, s17, 0xffff
  s_mov_b32 s54, 1966080
  s_mov_b32 s55, 0x20000
  s_mov_b32 s56, s18
  s_and_b32 s57, s19, 0xffff
  s_mov_b32 s58, 1966080
  s_mov_b32 s59, 0x20000
  v_lshrrev_b32 v7, 1, v1
  v_mul_u32_u24 v7, 3072, v7
  v_and_b32 v8, 1, v1
  v_lshl_add_u32 v7, v8, 4, v7
  s_mul_i32 s71, s64, 491520
  s_lshl_b32 s72, s70, 5
  s_add_u32 s71, s71, s72
  s_mul_i32 s73, s64, 5120
  s_add_u32 m0, s73, 13312
  s_add_u32 s72, s71, 0
  buffer_load_dwordx4 v7, s[52:55], s72 offen nt lds
  s_add_u32 m0, s73, 14336
  s_add_u32 s72, s71, 98304
  buffer_load_dwordx4 v7, s[52:55], s72 offen nt lds
  s_add_u32 m0, s73, 15360
  s_add_u32 s72, s71, 196608
  buffer_load_dwordx4 v7, s[52:55], s72 offen nt lds
  s_mul_i32 s71, s70, 20480
  s_add_u32 s71, s71, s73
L_wd2:
  v_lshlrev_b32 v6, 4, v5
  ds_read_b128 v[44:47], v6 offset:0
  ds_read_b128 v[48:51], v6 offset:64
  ds_read_b128 v[52:55], v6 offset:128
  ds_read_b128 v[56:59], v6 offset:192
  ds_read_b128 v[60:63], v6 offset:256
  ds_read_b128 v[64:67], v6 offset:320
  s_waitcnt lgkmcnt(0)
  s_mul_i32 s71, s64, 1920
  s_add_u32 s71, s71, 512
  v_lshl_add_u32 v18, v5, 4, s71
  v_mov_b32 v19, 0xff800000
  s_mov_b32 s99, 13
  ds_read_b128 v[68:71], v200 offset:0
  ds_read_b128 v[72:75], v201 offset:0
  ds_read_b128 v[76:79], v200 offset:128
  ds_read_b128 v[80:83], v201 offset:128
  ds_read_b128 v[84:87], v200 offset:256
  ds_read_b128 v[88:91], v201 offset:256
  ds_read_b128 v[92:95], v200 offset:6144
  ds_read_b128 v[96:99], v201 offset:6144
  ds_read_b128 v[100:103], v200 offset:6272
  ds_read_b128 v[104:107], v201 offset:6272
  ds_read_b128 v[108:111], v200 offset:6400
  ds_read_b128 v[112:115], v201 offset:6400
  s_waitcnt lgkmcnt(11)
  v_mfma_f32_16x16x32_bf16 v[24:27], v[68:71], v[44:47], 0
  s_waitcnt lgkmcnt(10)
  v_mfma_f32_16x16x32_bf16 v[24:27], v[72:75], v[48:51], v[24:27]
  s_waitcnt lgkmcnt(9)
  v_mfma_f32_16x16x32_bf16 v[24:27], v[76:79], v[52:55], v[24:27]
  s_waitcnt lgkmcnt(8)
  v_mfma_f32_16x16x32_bf16 v[24:27], v[80:83], v[56:59], v[24:27]
  s_waitcnt lgkmcnt(7)
  v_mfma_f32_16x16x32_bf16 v[24:27], v[84:87], v[60:63], v[24:27]
  s_waitcnt lgkmcnt(6)
  v_mfma_f32_16x16x32_bf16 v[24:27], v[88:91], v[64:67], v[24:27]
  s_waitcnt lgkmcnt(5)
  v_mfma_f32_16x16x32_bf16 v[28:31], v[92:95], v[44:47], 0
  s_waitcnt lgkmcnt(4)
  v_mfma_f32_16x16x32_bf16 v[28:31], v[96:99], v[48:51], v[28:31]
  s_waitcnt lgkmcnt(3)
  v_mfma_f32_16x16x32_bf16 v[28:31], v[100:103], v[52:55], v[28:31]
  s_waitcnt lgkmcnt(2)
  v_mfma_f32_16x16x32_bf16 v[28:31], v[104:107], v[56:59], v[28:31]
  s_waitcnt lgkmcnt(1)
  v_mfma_f32_16x16x32_bf16 v[28:31], v[108:111], v[60:63], v[28:31]
  s_waitcnt lgkmcnt(0)
  v_mfma_f32_16x16x32_bf16 v[28:31], v[112:115], v[64:67], v[28:31]
  s_nop 6
  v_cvt_pk_bf16_f32 v32, v24, v25
  v_cvt_pk_bf16_f32 v33, v26, v27
  v_cvt_pk_bf16_f32 v34, v28, v29
  v_cvt_pk_bf16_f32 v35, v30, v31
  v_lshlrev_b32 v24, 16, v32
  v_and_b32 v25, 0xffff0000, v32
  v_lshlrev_b32 v26, 16, v33
  v_and_b32 v27, 0xffff0000, v33
  v_lshlrev_b32 v28, 16, v34
  v_and_b32 v29, 0xffff0000, v34
  v_lshlrev_b32 v30, 16, v35
  v_and_b32 v31, 0xffff0000, v35
  v_mul_f32 v24, s89, v24
  v_mul_f32 v25, s89, v25
  v_mul_f32 v26, s89, v26
  v_mul_f32 v27, s89, v27
  v_mul_f32 v28, s89, v28
  v_mul_f32 v29, s89, v29
  v_mul_f32 v30, s89, v30
  v_mul_f32 v31, s89, v31
  v_cvt_pk_bf16_f32 v32, v24, v25
  v_cvt_pk_bf16_f32 v33, v26, v27
  v_cvt_pk_bf16_f32 v34, v28, v29
  v_cvt_pk_bf16_f32 v35, v30, v31
  v_lshlrev_b32 v24, 16, v32
  v_and_b32 v25, 0xffff0000, v32
  v_lshlrev_b32 v26, 16, v33
  v_and_b32 v27, 0xffff0000, v33
  v_lshlrev_b32 v28, 16, v34
  v_and_b32 v29, 0xffff0000, v34
  v_lshlrev_b32 v30, 16, v35
  v_and_b32 v31, 0xffff0000, v35
  s_mov_b32 exec_lo, 0x00010001
  s_mov_b32 exec_hi, 0x00010001
  ds_write_b128 v18, v[32:35] offset:0
  s_mov_b64 exec, -1
  v_max3_f32 v19, v19, v24, v25
  v_max3_f32 v19, v19, v26, v27
  v_max3_f32 v19, v19, v28, v29
  v_max3_f32 v19, v19, v30, v31
  s_branch L_kloop
L_chk:
  s_load_dword s72, s[22:23], 0x80
  s_mov_b32 s83, 65536
L_chk_poll:
  s_waitcnt lgkmcnt(0)
  s_cmp_ge_u32 s72, 32
  s_cbranch_scc1 L_kloop
  s_sleep 32
  s_load_dword s72, s[22:23], 0x80 glc
  s_sub_u32 s83, s83, 1
  s_cmp_lg_u32 s83, 0
  s_cbranch_scc1 L_chk_poll
  s_branch L_end
L_kloop:
  s_lshl_b32 s81, s84, 5
  s_add_u32 s81, s81, s90
  s_add_u32 s81, s81, s91
  s_and_b32 s81, s81, 1023
  s_mul_i32 s81, s81, 12288
  s_add_u32 s84, s84, 1
  s_sub_u32 s85, s85, 1
  s_waitcnt vmcnt(3)
  s_mov_b32 m0, s75
  s_add_u32 s71, s81, 0
  buffer_load_dwordx4 v196, s[28:31], s71 offen offset:0 nt lds
  buffer_load_dwordx4 v197, s[28:31], s71 offen offset:1024 nt lds
  buffer_load_dwordx4 v198, s[28:31], s71 offen offset:2048 nt lds
  s_waitcnt vmcnt(3)
  s_mov_b32 m0, s75
  s_add_u32 s71, s81, 0
  buffer_load_dwordx4 v196, s[28:31], s71 offen offset:3072 nt lds
  s_mov_b32 m0, s76
  s_add_u32 s71, s81, 4096
  buffer_load_dwordx4 v197, s[28:31], s71 offen offset:0 nt lds
  buffer_load_dwordx4 v198, s[28:31], s71 offen offset:1024 nt lds
  ds_read_b128 v[68:71], v200 offset:12288
  ds_read_b128 v[72:75], v201 offset:12288
  ds_read_b128 v[76:79], v200 offset:12416
  ds_read_b128 v[80:83], v201 offset:12416
  ds_read_b128 v[84:87], v200 offset:12544
  ds_read_b128 v[88:91], v201 offset:12544
  s_waitcnt lgkmcnt(5)
  v_mfma_f32_16x16x32_bf16 v[24:27], v[68:71], v[44:47], 0
  s_waitcnt lgkmcnt(4)
  v_mfma_f32_16x16x32_bf16 v[24:27], v[72:75], v[48:51], v[24:27]
  s_waitcnt lgkmcnt(3)
  v_mfma_f32_16x16x32_bf16 v[24:27], v[76:79], v[52:55], v[24:27]
  s_waitcnt lgkmcnt(2)
  v_mfma_f32_16x16x32_bf16 v[24:27], v[80:83], v[56:59], v[24:27]
  s_waitcnt lgkmcnt(1)
  v_mfma_f32_16x16x32_bf16 v[24:27], v[84:87], v[60:63], v[24:27]
  s_waitcnt lgkmcnt(0)
  v_mfma_f32_16x16x32_bf16 v[24:27], v[88:91], v[64:67], v[24:27]
  s_waitcnt vmcnt(3)
  s_mov_b32 m0, s76
  s_add_u32 s71, s81, 4096
  buffer_load_dwordx4 v196, s[28:31], s71 offen offset:2048 nt lds
  buffer_load_dwordx4 v197, s[28:31], s71 offen offset:3072 nt lds
  s_mov_b32 m0, s77
  s_add_u32 s71, s81, 8192
  buffer_load_dwordx4 v198, s[28:31], s71 offen offset:0 nt lds
  s_waitcnt vmcnt(3)
  s_mov_b32 m0, s77
  s_add_u32 s71, s81, 8192
  buffer_load_dwordx4 v196, s[28:31], s71 offen offset:1024 nt lds
  buffer_load_dwordx4 v197, s[28:31], s71 offen offset:2048 nt lds
  buffer_load_dwordx4 v198, s[28:31], s71 offen offset:3072 nt lds
  ds_read_b128 v[92:95], v200 offset:18432
  ds_read_b128 v[96:99], v201 offset:18432
  ds_read_b128 v[100:103], v200 offset:18560
  ds_read_b128 v[104:107], v201 offset:18560
  ds_read_b128 v[108:111], v200 offset:18688
  ds_read_b128 v[112:115], v201 offset:18688
  s_waitcnt lgkmcnt(5)
  v_mfma_f32_16x16x32_bf16 v[28:31], v[92:95], v[44:47], 0
  s_waitcnt lgkmcnt(4)
  v_mfma_f32_16x16x32_bf16 v[28:31], v[96:99], v[48:51], v[28:31]
  s_waitcnt lgkmcnt(3)
  v_mfma_f32_16x16x32_bf16 v[28:31], v[100:103], v[52:55], v[28:31]
  s_waitcnt lgkmcnt(2)
  v_mfma_f32_16x16x32_bf16 v[28:31], v[104:107], v[56:59], v[28:31]
  s_waitcnt lgkmcnt(1)
  v_mfma_f32_16x16x32_bf16 v[28:31], v[108:111], v[60:63], v[28:31]
  s_waitcnt lgkmcnt(0)
  v_mfma_f32_16x16x32_bf16 v[28:31], v[112:115], v[64:67], v[28:31]
  s_nop 6
  v_cvt_pk_bf16_f32 v32, v24, v25
  v_cvt_pk_bf16_f32 v33, v26, v27
  v_cvt_pk_bf16_f32 v34, v28, v29
  v_cvt_pk_bf16_f32 v35, v30, v31
  v_lshlrev_b32 v24, 16, v32
  v_and_b32 v25, 0xffff0000, v32
  v_lshlrev_b32 v26, 16, v33
  v_and_b32 v27, 0xffff0000, v33
  v_lshlrev_b32 v28, 16, v34
  v_and_b32 v29, 0xffff0000, v34
  v_lshlrev_b32 v30, 16, v35
  v_and_b32 v31, 0xffff0000, v35
  v_mul_f32 v24, s89, v24
  v_mul_f32 v25, s89, v25
  v_mul_f32 v26, s89, v26
  v_mul_f32 v27, s89, v27
  v_mul_f32 v28, s89, v28
  v_mul_f32 v29, s89, v29
  v_mul_f32 v30, s89, v30
  v_mul_f32 v31, s89, v31
  v_cvt_pk_bf16_f32 v32, v24, v25
  v_cvt_pk_bf16_f32 v33, v26, v27
  v_cvt_pk_bf16_f32 v34, v28, v29
  v_cvt_pk_bf16_f32 v35, v30, v31
  v_lshlrev_b32 v24, 16, v32
  v_and_b32 v25, 0xffff0000, v32
  v_lshlrev_b32 v26, 16, v33
  v_and_b32 v27, 0xffff0000, v33
  v_lshlrev_b32 v28, 16, v34
  v_and_b32 v29, 0xffff0000, v34
  v_lshlrev_b32 v30, 16, v35
  v_and_b32 v31, 0xffff0000, v35
  s_mov_b32 exec_lo, 0x00010001
  s_mov_b32 exec_hi, 0x00010001
  ds_write_b128 v18, v[32:35] offset:64
  s_mov_b64 exec, -1
  v_max3_f32 v19, v19, v24, v25
  v_max3_f32 v19, v19, v26, v27
  v_max3_f32 v19, v19, v28, v29
  v_max3_f32 v19, v19, v30, v31
  s_lshl_b32 s81, s84, 5
  s_add_u32 s81, s81, s90
  s_add_u32 s81, s81, s91
  s_and_b32 s81, s81, 1023
  s_mul_i32 s81, s81, 12288
  s_add_u32 s84, s84, 1
  s_sub_u32 s85, s85, 1
  s_waitcnt vmcnt(3)
  s_mov_b32 m0, s78
  s_add_u32 s71, s81, 0
  buffer_load_dwordx4 v196, s[28:31], s71 offen offset:0 nt lds
  buffer_load_dwordx4 v197, s[28:31], s71 offen offset:1024 nt lds
  buffer_load_dwordx4 v198, s[28:31], s71 offen offset:2048 nt lds
  s_waitcnt vmcnt(3)
  s_mov_b32 m0, s78
  s_add_u32 s71, s81, 0
  buffer_load_dwordx4 v196, s[28:31], s71 offen offset:3072 nt lds
  s_mov_b32 m0, s79
  s_add_u32 s71, s81, 4096
  buffer_load_dwordx4 v197, s[28:31], s71 offen offset:0 nt lds
  buffer_load_dwordx4 v198, s[28:31], s71 offen offset:1024 nt lds
  ds_read_b128 v[68:71], v200 offset:0
  ds_read_b128 v[72:75], v201 offset:0
  ds_read_b128 v[76:79], v200 offset:128
  ds_read_b128 v[80:83], v201 offset:128
  ds_read_b128 v[84:87], v200 offset:256
  ds_read_b128 v[88:91], v201 offset:256
  s_waitcnt lgkmcnt(5)
  v_mfma_f32_16x16x32_bf16 v[24:27], v[68:71], v[44:47], 0
  s_waitcnt lgkmcnt(4)
  v_mfma_f32_16x16x32_bf16 v[24:27], v[72:75], v[48:51], v[24:27]
  s_waitcnt lgkmcnt(3)
  v_mfma_f32_16x16x32_bf16 v[24:27], v[76:79], v[52:55], v[24:27]
  s_waitcnt lgkmcnt(2)
  v_mfma_f32_16x16x32_bf16 v[24:27], v[80:83], v[56:59], v[24:27]
  s_waitcnt lgkmcnt(1)
  v_mfma_f32_16x16x32_bf16 v[24:27], v[84:87], v[60:63], v[24:27]
  s_waitcnt lgkmcnt(0)
  v_mfma_f32_16x16x32_bf16 v[24:27], v[88:91], v[64:67], v[24:27]
  s_waitcnt vmcnt(3)
  s_mov_b32 m0, s79
  s_add_u32 s71, s81, 4096
  buffer_load_dwordx4 v196, s[28:31], s71 offen offset:2048 nt lds
  buffer_load_dwordx4 v197, s[28:31], s71 offen offset:3072 nt lds
  s_mov_b32 m0, s80
  s_add_u32 s71, s81, 8192
  buffer_load_dwordx4 v198, s[28:31], s71 offen offset:0 nt lds
  s_waitcnt vmcnt(3)
  s_mov_b32 m0, s80
  s_add_u32 s71, s81, 8192
  buffer_load_dwordx4 v196, s[28:31], s71 offen offset:1024 nt lds
  buffer_load_dwordx4 v197, s[28:31], s71 offen offset:2048 nt lds
  buffer_load_dwordx4 v198, s[28:31], s71 offen offset:3072 nt lds
  ds_read_b128 v[92:95], v200 offset:6144
  ds_read_b128 v[96:99], v201 offset:6144
  ds_read_b128 v[100:103], v200 offset:6272
  ds_read_b128 v[104:107], v201 offset:6272
  ds_read_b128 v[108:111], v200 offset:6400
  ds_read_b128 v[112:115], v201 offset:6400
  s_waitcnt lgkmcnt(5)
  v_mfma_f32_16x16x32_bf16 v[28:31], v[92:95], v[44:47], 0
  s_waitcnt lgkmcnt(4)
  v_mfma_f32_16x16x32_bf16 v[28:31], v[96:99], v[48:51], v[28:31]
  s_waitcnt lgkmcnt(3)
  v_mfma_f32_16x16x32_bf16 v[28:31], v[100:103], v[52:55], v[28:31]
  s_waitcnt lgkmcnt(2)
  v_mfma_f32_16x16x32_bf16 v[28:31], v[104:107], v[56:59], v[28:31]
  s_waitcnt lgkmcnt(1)
  v_mfma_f32_16x16x32_bf16 v[28:31], v[108:111], v[60:63], v[28:31]
  s_waitcnt lgkmcnt(0)
  v_mfma_f32_16x16x32_bf16 v[28:31], v[112:115], v[64:67], v[28:31]
  s_nop 6
  v_cvt_pk_bf16_f32 v32, v24, v25
  v_cvt_pk_bf16_f32 v33, v26, v27
  v_cvt_pk_bf16_f32 v34, v28, v29
  v_cvt_pk_bf16_f32 v35, v30, v31
  v_lshlrev_b32 v24, 16, v32
  v_and_b32 v25, 0xffff0000, v32
  v_lshlrev_b32 v26, 16, v33
  v_and_b32 v27, 0xffff0000, v33
  v_lshlrev_b32 v28, 16, v34
  v_and_b32 v29, 0xffff0000, v34
  v_lshlrev_b32 v30, 16, v35
  v_and_b32 v31, 0xffff0000, v35
  v_mul_f32 v24, s89, v24
  v_mul_f32 v25, s89, v25
  v_mul_f32 v26, s89, v26
  v_mul_f32 v27, s89, v27
  v_mul_f32 v28, s89, v28
  v_mul_f32 v29, s89, v29
  v_mul_f32 v30, s89, v30
  v_mul_f32 v31, s89, v31
  v_cvt_pk_bf16_f32 v32, v24, v25
  v_cvt_pk_bf16_f32 v33, v26, v27
  v_cvt_pk_bf16_f32 v34, v28, v29
  v_cvt_pk_bf16_f32 v35, v30, v31
  v_lshlrev_b32 v24, 16, v32
  v_and_b32 v25, 0xffff0000, v32
  v_lshlrev_b32 v26, 16, v33
  v_and_b32 v27, 0xffff0000, v33
  v_lshlrev_b32 v28, 16, v34
  v_and_b32 v29, 0xffff0000, v34
  v_lshlrev_b32 v30, 16, v35
  v_and_b32 v31, 0xffff0000, v35
  s_mov_b32 exec_lo, 0x00010001
  s_mov_b32 exec_hi, 0x00010001
  ds_write_b128 v18, v[32:35] offset:128
  s_mov_b64 exec, -1
  v_max3_f32 v19, v19, v24, v25
  v_max3_f32 v19, v19, v26, v27
  v_max3_f32 v19, v19, v28, v29
  v_max3_f32 v19, v19, v30, v31
  v_add_u32 v18, 128, v18
  s_sub_u32 s99, s99, 1
  s_cmp_eq_u32 s84, s98
  s_cbranch_scc1 L_chk
  s_cmp_lg_u32 s99, 0
  s_cbranch_scc1 L_kloop
  s_mov_b32 s84, 0
  s_lshl_b32 s81, s84, 5
  s_add_u32 s81, s81, s90
  s_add_u32 s81, s81, s91
  s_and_b32 s81, s81, 1023
  s_mul_i32 s81, s81, 12288
  s_add_u32 s84, s84, 1
  s_sub_u32 s85, s85, 1
  s_waitcnt vmcnt(3)
  s_mov_b32 m0, s75
  s_add_u32 s71, s81, 0
  buffer_load_dwordx4 v196, s[32:35], s71 offen offset:0 nt lds
  buffer_load_dwordx4 v197, s[32:35], s71 offen offset:1024 nt lds
  buffer_load_dwordx4 v198, s[32:35], s71 offen offset:2048 nt lds
  s_waitcnt vmcnt(3)
  s_mov_b32 m0, s75
  s_add_u32 s71, s81, 0
  buffer_load_dwordx4 v196, s[32:35], s71 offen offset:3072 nt lds
  s_mov_b32 m0, s76
  s_add_u32 s71, s81, 4096
  buffer_load_dwordx4 v197, s[32:35], s71 offen offset:0 nt lds
  buffer_load_dwordx4 v198, s[32:35], s71 offen offset:1024 nt lds
  ds_read_b128 v[68:71], v200 offset:12288
  ds_read_b128 v[72:75], v201 offset:12288
  ds_read_b128 v[76:79], v200 offset:12416
  ds_read_b128 v[80:83], v201 offset:12416
  ds_read_b128 v[84:87], v200 offset:12544
  ds_read_b128 v[88:91], v201 offset:12544
  s_waitcnt lgkmcnt(5)
  v_mfma_f32_16x16x32_bf16 v[24:27], v[68:71], v[44:47], 0
  s_waitcnt lgkmcnt(4)
  v_mfma_f32_16x16x32_bf16 v[24:27], v[72:75], v[48:51], v[24:27]
  s_waitcnt lgkmcnt(3)
  v_mfma_f32_16x16x32_bf16 v[24:27], v[76:79], v[52:55], v[24:27]
  s_waitcnt lgkmcnt(2)
  v_mfma_f32_16x16x32_bf16 v[24:27], v[80:83], v[56:59], v[24:27]
  s_waitcnt lgkmcnt(1)
  v_mfma_f32_16x16x32_bf16 v[24:27], v[84:87], v[60:63], v[24:27]
  s_waitcnt lgkmcnt(0)
  v_mfma_f32_16x16x32_bf16 v[24:27], v[88:91], v[64:67], v[24:27]
  s_waitcnt vmcnt(3)
  s_mov_b32 m0, s76
  s_add_u32 s71, s81, 4096
  buffer_load_dwordx4 v196, s[32:35], s71 offen offset:2048 nt lds
  buffer_load_dwordx4 v197, s[32:35], s71 offen offset:3072 nt lds
  s_mov_b32 m0, s77
  s_add_u32 s71, s81, 8192
  buffer_load_dwordx4 v198, s[32:35], s71 offen offset:0 nt lds
  s_waitcnt vmcnt(3)
  s_mov_b32 m0, s77
  s_add_u32 s71, s81, 8192
  buffer_load_dwordx4 v196, s[32:35], s71 offen offset:1024 nt lds
  buffer_load_dwordx4 v197, s[32:35], s71 offen offset:2048 nt lds
  buffer_load_dwordx4 v198, s[32:35], s71 offen offset:3072 nt lds
  ds_read_b128 v[92:95], v200 offset:18432
  ds_read_b128 v[96:99], v201 offset:18432
  ds_read_b128 v[100:103], v200 offset:18560
  ds_read_b128 v[104:107], v201 offset:18560
  ds_read_b128 v[108:111], v200 offset:18688
  ds_read_b128 v[112:115], v201 offset:18688
  s_waitcnt lgkmcnt(5)
  v_mfma_f32_16x16x32_bf16 v[28:31], v[92:95], v[44:47], 0
  s_waitcnt lgkmcnt(4)
  v_mfma_f32_16x16x32_bf16 v[28:31], v[96:99], v[48:51], v[28:31]
  s_waitcnt lgkmcnt(3)
  v_mfma_f32_16x16x32_bf16 v[28:31], v[100:103], v[52:55], v[28:31]
  s_waitcnt lgkmcnt(2)
  v_mfma_f32_16x16x32_bf16 v[28:31], v[104:107], v[56:59], v[28:31]
  s_waitcnt lgkmcnt(1)
  v_mfma_f32_16x16x32_bf16 v[28:31], v[108:111], v[60:63], v[28:31]
  s_waitcnt lgkmcnt(0)
  v_mfma_f32_16x16x32_bf16 v[28:31], v[112:115], v[64:67], v[28:31]
  s_nop 6
  v_cvt_pk_bf16_f32 v32, v24, v25
  v_cvt_pk_bf16_f32 v33, v26, v27
  v_cvt_pk_bf16_f32 v34, v28, v29
  v_cvt_pk_bf16_f32 v35, v30, v31
  v_lshlrev_b32 v24, 16, v32
  v_and_b32 v25, 0xffff0000, v32
  v_lshlrev_b32 v26, 16, v33
  v_and_b32 v27, 0xffff0000, v33
  v_lshlrev_b32 v28, 16, v34
  v_and_b32 v29, 0xffff0000, v34
  v_lshlrev_b32 v30, 16, v35
  v_and_b32 v31, 0xffff0000, v35
  v_mul_f32 v24, s89, v24
  v_mul_f32 v25, s89, v25
  v_mul_f32 v26, s89, v26
  v_mul_f32 v27, s89, v27
  v_mul_f32 v28, s89, v28
  v_mul_f32 v29, s89, v29
  v_mul_f32 v30, s89, v30
  v_mul_f32 v31, s89, v31
  v_cvt_pk_bf16_f32 v32, v24, v25
  v_cvt_pk_bf16_f32 v33, v26, v27
  v_cvt_pk_bf16_f32 v34, v28, v29
  v_cvt_pk_bf16_f32 v35, v30, v31
  v_lshlrev_b32 v24, 16, v32
  v_and_b32 v25, 0xffff0000, v32
  v_lshlrev_b32 v26, 16, v33
  v_and_b32 v27, 0xffff0000, v33
  v_lshlrev_b32 v28, 16, v34
  v_and_b32 v29, 0xffff0000, v34
  v_lshlrev_b32 v30, 16, v35
  v_and_b32 v31, 0xffff0000, v35
  s_mov_b32 exec_lo, 0x00010001
  s_mov_b32 exec_hi, 0x00010001
  ds_write_b128 v18, v[32:35] offset:64
  s_mov_b64 exec, -1
  v_max3_f32 v19, v19, v24, v25
  v_max3_f32 v19, v19, v26, v27
  v_max3_f32 v19, v19, v28, v29
  v_max3_f32 v19, v19, v30, v31
  v_mov_b32 v6, v19
  s_nop 1
  v_permlane16_swap_b32 v19, v6
  v_max_f32 v19, v19, v6
  v_mov_b32 v6, v19
  s_nop 1
  v_permlane32_swap_b32 v19, v6
  v_max_f32 v19, v19, v6
  v_mul_f32 v16, s88, v19
  v_subrev_u32 v18, 1664, v18
  s_mov_b32 s99, 13
  s_waitcnt lgkmcnt(0)
L_vloop:
  s_lshl_b32 s81, s84, 5
  s_add_u32 s81, s81, s90
  s_add_u32 s81, s81, s91
  s_and_b32 s81, s81, 1023
  s_mul_i32 s81, s81, 12288
  s_add_u32 s84, s84, 1
  s_sub_u32 s85, s85, 1
  ds_read_b128 v[32:35], v18 offset:0
  s_waitcnt lgkmcnt(0)
  v_lshlrev_b32 v24, 16, v32
  v_and_b32 v25, 0xffff0000, v32
  v_lshlrev_b32 v26, 16, v33
  v_and_b32 v27, 0xffff0000, v33
  v_lshlrev_b32 v28, 16, v34
  v_and_b32 v29, 0xffff0000, v34
  v_lshlrev_b32 v30, 16, v35
  v_and_b32 v31, 0xffff0000, v35
  v_fma_f32 v36, v24, s88, -v16
  v_fma_f32 v37, v25, s88, -v16
  v_fma_f32 v38, v26, s88, -v16
  v_fma_f32 v39, v27, s88, -v16
  v_fma_f32 v40, v28, s88, -v16
  v_fma_f32 v41, v29, s88, -v16
  v_fma_f32 v42, v30, s88, -v16
  v_fma_f32 v43, v31, s88, -v16
  v_exp_f32 v36, v36
  v_exp_f32 v37, v37
  v_exp_f32 v38, v38
  v_exp_f32 v39, v39
  v_exp_f32 v40, v40
  v_exp_f32 v41, v41
  v_exp_f32 v42, v42
  v_exp_f32 v43, v43
  s_nop 0
  v_cvt_pk_bf16_f32 v32, v36, v37
  v_cvt_pk_bf16_f32 v33, v38, v39
  v_cvt_pk_bf16_f32 v34, v40, v41
  v_cvt_pk_bf16_f32 v35, v42, v43
  v_add_f32 v36, v36, v40
  v_add_f32 v37, v37, v41
  v_add_f32 v38, v38, v42
  v_add_f32 v39, v39, v43
  v_add_f32 v36, v36, v37
  v_add_f32 v38, v38, v39
  v_add_f32 v36, v36, v38
  v_add_f32 v17, v17, v36
  s_waitcnt vmcnt(3)
  s_mov_b32 m0, s78
  s_add_u32 s71, s81, 0
  buffer_load_dwordx4 v196, s[32:35], s71 offen offset:0 nt lds
  buffer_load_dwordx4 v197, s[32:35], s71 offen offset:1024 nt lds
  buffer_load_dwordx4 v198, s[32:35], s71 offen offset:2048 nt lds
  s_waitcnt vmcnt(3)
  s_mov_b32 m0, s78
  s_add_u32 s71, s81, 0
  buffer_load_dwordx4 v196, s[32:35], s71 offen offset:3072 nt lds
  s_mov_b32 m0, s79
  s_add_u32 s71, s81, 4096
  buffer_load_dwordx4 v197, s[32:35], s71 offen offset:0 nt lds
  buffer_load_dwordx4 v198, s[32:35], s71 offen offset:1024 nt lds
  s_waitcnt vmcnt(3)
  s_mov_b32 m0, s79
  s_add_u32 s71, s81, 4096
  buffer_load_dwordx4 v196, s[32:35], s71 offen offset:2048 nt lds
  buffer_load_dwordx4 v197, s[32:35], s71 offen offset:3072 nt lds
  s_mov_b32 m0, s80
  s_add_u32 s71, s81, 8192
  buffer_load_dwordx4 v198, s[32:35], s71 offen offset:0 nt lds
  s_waitcnt vmcnt(3)
  s_mov_b32 m0, s80
  s_add_u32 s71, s81, 8192
  buffer_load_dwordx4 v196, s[32:35], s71 offen offset:1024 nt lds
  buffer_load_dwordx4 v197, s[32:35], s71 offen offset:2048 nt lds
  buffer_load_dwordx4 v198, s[32:35], s71 offen offset:3072 nt lds
  ds_read_b64_tr_b16 v[68:69], v204 offset:0
  ds_read_b64_tr_b16 v[70:71], v204 offset:6144
  ds_read_b64_tr_b16 v[72:73], v205 offset:0
  ds_read_b64_tr_b16 v[74:75], v205 offset:6144
  ds_read_b64_tr_b16 v[76:77], v206 offset:0
  ds_read_b64_tr_b16 v[78:79], v206 offset:6144
  ds_read_b64_tr_b16 v[80:81], v207 offset:0
  ds_read_b64_tr_b16 v[82:83], v207 offset:6144
  ds_read_b64_tr_b16 v[84:85], v204 offset:128
  ds_read_b64_tr_b16 v[86:87], v204 offset:6272
  ds_read_b64_tr_b16 v[88:89], v205 offset:128
  ds_read_b64_tr_b16 v[90:91], v205 offset:6272
  ds_read_b64_tr_b16 v[92:93], v206 offset:128
  ds_read_b64_tr_b16 v[94:95], v206 offset:6272
  s_waitcnt lgkmcnt(12)
  v_mfma_f32_16x16x32_bf16 v[116:119], v[32:35], v[68:71], v[116:119]
  ds_read_b64_tr_b16 v[96:97], v207 offset:128
  ds_read_b64_tr_b16 v[98:99], v207 offset:6272
  s_waitcnt lgkmcnt(12)
  v_mfma_f32_16x16x32_bf16 v[120:123], v[32:35], v[72:75], v[120:123]
  ds_read_b64_tr_b16 v[100:101], v204 offset:256
  ds_read_b64_tr_b16 v[102:103], v204 offset:6400
  s_waitcnt lgkmcnt(12)
  v_mfma_f32_16x16x32_bf16 v[124:127], v[32:35], v[76:79], v[124:127]
  ds_read_b64_tr_b16 v[104:105], v205 offset:256
  ds_read_b64_tr_b16 v[106:107], v205 offset:6400
  s_waitcnt lgkmcnt(12)
  v_mfma_f32_16x16x32_bf16 v[128:131], v[32:35], v[80:83], v[128:131]
  ds_read_b64_tr_b16 v[108:109], v206 offset:256
  ds_read_b64_tr_b16 v[110:111], v206 offset:6400
  s_waitcnt lgkmcnt(12)
  v_mfma_f32_16x16x32_bf16 v[132:135], v[32:35], v[84:87], v[132:135]
  ds_read_b64_tr_b16 v[112:113], v207 offset:256
  ds_read_b64_tr_b16 v[114:115], v207 offset:6400
  s_waitcnt lgkmcnt(12)
  v_mfma_f32_16x16x32_bf16 v[136:139], v[32:35], v[88:91], v[136:139]
  s_waitcnt lgkmcnt(10)
  v_mfma_f32_16x16x32_bf16 v[140:143], v[32:35], v[92:95], v[140:143]
  s_waitcnt lgkmcnt(8)
  v_mfma_f32_16x16x32_bf16 v[144:147], v[32:35], v[96:99], v[144:147]
  s_waitcnt lgkmcnt(6)
  v_mfma_f32_16x16x32_bf16 v[148:151], v[32:35], v[100:103], v[148:151]
  s_waitcnt lgkmcnt(4)
  v_mfma_f32_16x16x32_bf16 v[152:155], v[32:35], v[104:107], v[152:155]
  s_waitcnt lgkmcnt(2)
  v_mfma_f32_16x16x32_bf16 v[156:159], v[32:35], v[108:111], v[156:159]
  s_waitcnt lgkmcnt(0)
  v_mfma_f32_16x16x32_bf16 v[160:163], v[32:35], v[112:115], v[160:163]
  s_lshl_b32 s81, s84, 5
  s_add_u32 s81, s81, s90
  s_add_u32 s81, s81, s91
  s_and_b32 s81, s81, 1023
  s_mul_i32 s81, s81, 12288
  s_add_u32 s84, s84, 1
  s_sub_u32 s85, s85, 1
  ds_read_b128 v[32:35], v18 offset:64
  s_waitcnt lgkmcnt(0)
  v_lshlrev_b32 v24, 16, v32
  v_and_b32 v25, 0xffff0000, v32
  v_lshlrev_b32 v26, 16, v33
  v_and_b32 v27, 0xffff0000, v33
  v_lshlrev_b32 v28, 16, v34
  v_and_b32 v29, 0xffff0000, v34
  v_lshlrev_b32 v30, 16, v35
  v_and_b32 v31, 0xffff0000, v35
  v_fma_f32 v36, v24, s88, -v16
  v_fma_f32 v37, v25, s88, -v16
  v_fma_f32 v38, v26, s88, -v16
  v_fma_f32 v39, v27, s88, -v16
  v_fma_f32 v40, v28, s88, -v16
  v_fma_f32 v41, v29, s88, -v16
  v_fma_f32 v42, v30, s88, -v16
  v_fma_f32 v43, v31, s88, -v16
  v_exp_f32 v36, v36
  v_exp_f32 v37, v37
  v_exp_f32 v38, v38
  v_exp_f32 v39, v39
  v_exp_f32 v40, v40
  v_exp_f32 v41, v41
  v_exp_f32 v42, v42
  v_exp_f32 v43, v43
  s_nop 0
  v_cvt_pk_bf16_f32 v32, v36, v37
  v_cvt_pk_bf16_f32 v33, v38, v39
  v_cvt_pk_bf16_f32 v34, v40, v41
  v_cvt_pk_bf16_f32 v35, v42, v43
  v_add_f32 v36, v36, v40
  v_add_f32 v37, v37, v41
  v_add_f32 v38, v38, v42
  v_add_f32 v39, v39, v43
  v_add_f32 v36, v36, v37
  v_add_f32 v38, v38, v39
  v_add_f32 v36, v36, v38
  v_add_f32 v17, v17, v36
  s_waitcnt vmcnt(3)
  s_mov_b32 m0, s75
  s_add_u32 s71, s81, 0
  buffer_load_dwordx4 v196, s[32:35], s71 offen offset:0 nt lds
  buffer_load_dwordx4 v197, s[32:35], s71 offen offset:1024 nt lds
  buffer_load_dwordx4 v198, s[32:35], s71 offen offset:2048 nt lds
  s_waitcnt vmcnt(3)
  s_mov_b32 m0, s75
  s_add_u32 s71, s81, 0
  buffer_load_dwordx4 v196, s[32:35], s71 offen offset:3072 nt lds
  s_mov_b32 m0, s76
  s_add_u32 s71, s81, 4096
  buffer_load_dwordx4 v197, s[32:35], s71 offen offset:0 nt lds
  buffer_load_dwordx4 v198, s[32:35], s71 offen offset:1024 nt lds
  s_waitcnt vmcnt(3)
  s_mov_b32 m0, s76
  s_add_u32 s71, s81, 4096
  buffer_load_dwordx4 v196, s[32:35], s71 offen offset:2048 nt lds
  buffer_load_dwordx4 v197, s[32:35], s71 offen offset:3072 nt lds
  s_mov_b32 m0, s77
  s_add_u32 s71, s81, 8192
  buffer_load_dwordx4 v198, s[32:35], s71 offen offset:0 nt lds
  s_waitcnt vmcnt(3)
  s_mov_b32 m0, s77
  s_add_u32 s71, s81, 8192
  buffer_load_dwordx4 v196, s[32:35], s71 offen offset:1024 nt lds
  buffer_load_dwordx4 v197, s[32:35], s71 offen offset:2048 nt lds
  buffer_load_dwordx4 v198, s[32:35], s71 offen offset:3072 nt lds
  ds_read_b64_tr_b16 v[68:69], v204 offset:12288
  ds_read_b64_tr_b16 v[70:71], v204 offset:18432
  ds_read_b64_tr_b16 v[72:73], v205 offset:12288
  ds_read_b64_tr_b16 v[74:75], v205 offset:18432
  ds_read_b64_tr_b16 v[76:77], v206 offset:12288
  ds_read_b64_tr_b16 v[78:79], v206 offset:18432
  ds_read_b64_tr_b16 v[80:81], v207 offset:12288
  ds_read_b64_tr_b16 v[82:83], v207 offset:18432
  ds_read_b64_tr_b16 v[84:85], v204 offset:12416
  ds_read_b64_tr_b16 v[86:87], v204 offset:18560
  ds_read_b64_tr_b16 v[88:89], v205 offset:12416
  ds_read_b64_tr_b16 v[90:91], v205 offset:18560
  ds_read_b64_tr_b16 v[92:93], v206 offset:12416
  ds_read_b64_tr_b16 v[94:95], v206 offset:18560
  s_waitcnt lgkmcnt(12)
  v_mfma_f32_16x16x32_bf16 v[116:119], v[32:35], v[68:71], v[116:119]
  ds_read_b64_tr_b16 v[96:97], v207 offset:12416
  ds_read_b64_tr_b16 v[98:99], v207 offset:18560
  s_waitcnt lgkmcnt(12)
  v_mfma_f32_16x16x32_bf16 v[120:123], v[32:35], v[72:75], v[120:123]
  ds_read_b64_tr_b16 v[100:101], v204 offset:12544
  ds_read_b64_tr_b16 v[102:103], v204 offset:18688
  s_waitcnt lgkmcnt(12)
  v_mfma_f32_16x16x32_bf16 v[124:127], v[32:35], v[76:79], v[124:127]
  ds_read_b64_tr_b16 v[104:105], v205 offset:12544
  ds_read_b64_tr_b16 v[106:107], v205 offset:18688
  s_waitcnt lgkmcnt(12)
  v_mfma_f32_16x16x32_bf16 v[128:131], v[32:35], v[80:83], v[128:131]
  ds_read_b64_tr_b16 v[108:109], v206 offset:12544
  ds_read_b64_tr_b16 v[110:111], v206 offset:18688
  s_waitcnt lgkmcnt(12)
  v_mfma_f32_16x16x32_bf16 v[132:135], v[32:35], v[84:87], v[132:135]
  ds_read_b64_tr_b16 v[112:113], v207 offset:12544
  ds_read_b64_tr_b16 v[114:115], v207 offset:18688
  s_waitcnt lgkmcnt(12)
  v_mfma_f32_16x16x32_bf16 v[136:139], v[32:35], v[88:91], v[136:139]
  s_waitcnt lgkmcnt(10)
  v_mfma_f32_16x16x32_bf16 v[140:143], v[32:35], v[92:95], v[140:143]
  s_waitcnt lgkmcnt(8)
  v_mfma_f32_16x16x32_bf16 v[144:147], v[32:35], v[96:99], v[144:147]
  s_waitcnt lgkmcnt(6)
  v_mfma_f32_16x16x32_bf16 v[148:151], v[32:35], v[100:103], v[148:151]
  s_waitcnt lgkmcnt(4)
  v_mfma_f32_16x16x32_bf16 v[152:155], v[32:35], v[104:107], v[152:155]
  s_waitcnt lgkmcnt(2)
  v_mfma_f32_16x16x32_bf16 v[156:159], v[32:35], v[108:111], v[156:159]
  s_waitcnt lgkmcnt(0)
  v_mfma_f32_16x16x32_bf16 v[160:163], v[32:35], v[112:115], v[160:163]
  v_add_u32 v18, 128, v18
  s_sub_u32 s99, s99, 1
  s_cmp_lg_u32 s99, 0
  s_cbranch_scc1 L_vloop
  s_lshl_b32 s81, s84, 5
  s_add_u32 s81, s81, s90
  s_add_u32 s81, s81, s91
  s_and_b32 s81, s81, 1023
  s_mul_i32 s81, s81, 12288
  s_add_u32 s84, s84, 1
  s_sub_u32 s85, s85, 1
  ds_read_b128 v[32:35], v18 offset:0
  s_waitcnt lgkmcnt(0)
  v_lshlrev_b32 v24, 16, v32
  v_and_b32 v25, 0xffff0000, v32
  v_lshlrev_b32 v26, 16, v33
  v_and_b32 v27, 0xffff0000, v33
  v_lshlrev_b32 v28, 16, v34
  v_and_b32 v29, 0xffff0000, v34
  v_lshlrev_b32 v30, 16, v35
  v_and_b32 v31, 0xffff0000, v35
  v_fma_f32 v36, v24, s88, -v16
  v_fma_f32 v37, v25, s88, -v16
  v_fma_f32 v38, v26, s88, -v16
  v_fma_f32 v39, v27, s88, -v16
  v_fma_f32 v40, v28, s88, -v16
  v_fma_f32 v41, v29, s88, -v16
  v_fma_f32 v42, v30, s88, -v16
  v_fma_f32 v43, v31, s88, -v16
  v_exp_f32 v36, v36
  v_exp_f32 v37, v37
  v_exp_f32 v38, v38
  v_exp_f32 v39, v39
  v_exp_f32 v40, v40
  v_exp_f32 v41, v41
  v_exp_f32 v42, v42
  v_exp_f32 v43, v43
  s_nop 0
  v_cvt_pk_bf16_f32 v32, v36, v37
  v_cvt_pk_bf16_f32 v33, v38, v39
  v_cvt_pk_bf16_f32 v34, v40, v41
  v_cvt_pk_bf16_f32 v35, v42, v43
  v_add_f32 v36, v36, v40
  v_add_f32 v37, v37, v41
  v_add_f32 v38, v38, v42
  v_add_f32 v39, v39, v43
  v_add_f32 v36, v36, v37
  v_add_f32 v38, v38, v39
  v_add_f32 v36, v36, v38
  v_add_f32 v17, v17, v36
  s_waitcnt vmcnt(3)
  s_mov_b32 m0, s78
  s_add_u32 s71, s81, 0
  buffer_load_dwordx4 v196, s[32:35], s71 offen offset:0 nt lds
  buffer_load_dwordx4 v197, s[32:35], s71 offen offset:1024 nt lds
  buffer_load_dwordx4 v198, s[32:35], s71 offen offset:2048 nt lds
  s_waitcnt vmcnt(3)
  s_mov_b32 m0, s78
  s_add_u32 s71, s81, 0
  buffer_load_dwordx4 v196, s[32:35], s71 offen offset:3072 nt lds
  s_mov_b32 m0, s79
  s_add_u32 s71, s81, 4096
  buffer_load_dwordx4 v197, s[32:35], s71 offen offset:0 nt lds
  buffer_load_dwordx4 v198, s[32:35], s71 offen offset:1024 nt lds
  s_waitcnt vmcnt(3)
  s_mov_b32 m0, s79
  s_add_u32 s71, s81, 4096
  buffer_load_dwordx4 v196, s[32:35], s71 offen offset:2048 nt lds
  buffer_load_dwordx4 v197, s[32:35], s71 offen offset:3072 nt lds
  s_mov_b32 m0, s80
  s_add_u32 s71, s81, 8192
  buffer_load_dwordx4 v198, s[32:35], s71 offen offset:0 nt lds
  s_waitcnt vmcnt(3)
  s_mov_b32 m0, s80
  s_add_u32 s71, s81, 8192
  buffer_load_dwordx4 v196, s[32:35], s71 offen offset:1024 nt lds
  buffer_load_dwordx4 v197, s[32:35], s71 offen offset:2048 nt lds
  buffer_load_dwordx4 v198, s[32:35], s71 offen offset:3072 nt lds
  ds_read_b64_tr_b16 v[68:69], v204 offset:0
  ds_read_b64_tr_b16 v[70:71], v204 offset:6144
  ds_read_b64_tr_b16 v[72:73], v205 offset:0
  ds_read_b64_tr_b16 v[74:75], v205 offset:6144
  ds_read_b64_tr_b16 v[76:77], v206 offset:0
  ds_read_b64_tr_b16 v[78:79], v206 offset:6144
  ds_read_b64_tr_b16 v[80:81], v207 offset:0
  ds_read_b64_tr_b16 v[82:83], v207 offset:6144
  ds_read_b64_tr_b16 v[84:85], v204 offset:128
  ds_read_b64_tr_b16 v[86:87], v204 offset:6272
  ds_read_b64_tr_b16 v[88:89], v205 offset:128
  ds_read_b64_tr_b16 v[90:91], v205 offset:6272
  ds_read_b64_tr_b16 v[92:93], v206 offset:128
  ds_read_b64_tr_b16 v[94:95], v206 offset:6272
  s_waitcnt lgkmcnt(12)
  v_mfma_f32_16x16x32_bf16 v[116:119], v[32:35], v[68:71], v[116:119]
  ds_read_b64_tr_b16 v[96:97], v207 offset:128
  ds_read_b64_tr_b16 v[98:99], v207 offset:6272
  s_waitcnt lgkmcnt(12)
  v_mfma_f32_16x16x32_bf16 v[120:123], v[32:35], v[72:75], v[120:123]
  ds_read_b64_tr_b16 v[100:101], v204 offset:256
  ds_read_b64_tr_b16 v[102:103], v204 offset:6400
  s_waitcnt lgkmcnt(12)
  v_mfma_f32_16x16x32_bf16 v[124:127], v[32:35], v[76:79], v[124:127]
  ds_read_b64_tr_b16 v[104:105], v205 offset:256
  ds_read_b64_tr_b16 v[106:107], v205 offset:6400
  s_waitcnt lgkmcnt(12)
  v_mfma_f32_16x16x32_bf16 v[128:131], v[32:35], v[80:83], v[128:131]
  ds_read_b64_tr_b16 v[108:109], v206 offset:256
  ds_read_b64_tr_b16 v[110:111], v206 offset:6400
  s_waitcnt lgkmcnt(12)
  v_mfma_f32_16x16x32_bf16 v[132:135], v[32:35], v[84:87], v[132:135]
  ds_read_b64_tr_b16 v[112:113], v207 offset:256
  ds_read_b64_tr_b16 v[114:115], v207 offset:6400
  s_waitcnt lgkmcnt(12)
  v_mfma_f32_16x16x32_bf16 v[136:139], v[32:35], v[88:91], v[136:139]
  s_waitcnt lgkmcnt(10)
  v_mfma_f32_16x16x32_bf16 v[140:143], v[32:35], v[92:95], v[140:143]
  s_waitcnt lgkmcnt(8)
  v_mfma_f32_16x16x32_bf16 v[144:147], v[32:35], v[96:99], v[144:147]
  s_waitcnt lgkmcnt(6)
  v_mfma_f32_16x16x32_bf16 v[148:151], v[32:35], v[100:103], v[148:151]
  s_waitcnt lgkmcnt(4)
  v_mfma_f32_16x16x32_bf16 v[152:155], v[32:35], v[104:107], v[152:155]
  s_waitcnt lgkmcnt(2)
  v_mfma_f32_16x16x32_bf16 v[156:159], v[32:35], v[108:111], v[156:159]
  s_waitcnt lgkmcnt(0)
  v_mfma_f32_16x16x32_bf16 v[160:163], v[32:35], v[112:115], v[160:163]
  ds_read_b128 v[32:35], v18 offset:64
  s_waitcnt lgkmcnt(0)
  v_lshlrev_b32 v24, 16, v32
  v_and_b32 v25, 0xffff0000, v32
  v_lshlrev_b32 v26, 16, v33
  v_and_b32 v27, 0xffff0000, v33
  v_lshlrev_b32 v28, 16, v34
  v_and_b32 v29, 0xffff0000, v34
  v_lshlrev_b32 v30, 16, v35
  v_and_b32 v31, 0xffff0000, v35
  v_fma_f32 v36, v24, s88, -v16
  v_fma_f32 v37, v25, s88, -v16
  v_fma_f32 v38, v26, s88, -v16
  v_fma_f32 v39, v27, s88, -v16
  v_fma_f32 v40, v28, s88, -v16
  v_fma_f32 v41, v29, s88, -v16
  v_fma_f32 v42, v30, s88, -v16
  v_fma_f32 v43, v31, s88, -v16
  v_exp_f32 v36, v36
  v_exp_f32 v37, v37
  v_exp_f32 v38, v38
  v_exp_f32 v39, v39
  v_exp_f32 v40, v40
  v_exp_f32 v41, v41
  v_exp_f32 v42, v42
  v_exp_f32 v43, v43
  s_nop 0
  v_cvt_pk_bf16_f32 v32, v36, v37
  v_cvt_pk_bf16_f32 v33, v38, v39
  v_cvt_pk_bf16_f32 v34, v40, v41
  v_cvt_pk_bf16_f32 v35, v42, v43
  v_add_f32 v36, v36, v40
  v_add_f32 v37, v37, v41
  v_add_f32 v38, v38, v42
  v_add_f32 v39, v39, v43
  v_add_f32 v36, v36, v37
  v_add_f32 v38, v38, v39
  v_add_f32 v36, v36, v38
  v_add_f32 v17, v17, v36
  s_mov_b32 s85, 0
L_loop:
  s_cmp_lg_u32 s85, 0
  s_cbranch_scc1 L_have
  s_mov_b32 s96, 1
  s_atomic_add s96, s[24:25], s97 glc
  s_waitcnt lgkmcnt(0)
  s_mov_b32 s72, s96
  s_cmp_ge_u32 s72, 24
  s_cbranch_scc1 L_lastv
  s_and_b32 s90, s72, 7
  s_lshl_b32 s90, s90, 2
  s_add_u32 s90, s90, s3
  s_and_b32 s72, s72, 0xf8
  s_lshr_b64 s[86:87], s[92:93], s72
  s_and_b32 s84, s86, 0xff
  s_lshr_b64 s[86:87], s[94:95], s72
  s_and_b32 s85, s86, 0xff
L_have:
  s_lshl_b32 s81, s84, 5
  s_add_u32 s81, s81, s90
  s_add_u32 s81, s81, s91
  s_and_b32 s81, s81, 1023
  s_mul_i32 s81, s81, 12288
  s_add_u32 s84, s84, 1
  s_sub_u32 s85, s85, 1
  s_waitcnt vmcnt(6)
  s_mov_b32 m0, s75
  s_add_u32 s71, s81, 0
  buffer_load_dwordx4 v196, s[28:31], s71 offen offset:0 nt lds
  buffer_load_dwordx4 v197, s[28:31], s71 offen offset:1024 nt lds
  buffer_load_dwordx4 v198, s[28:31], s71 offen offset:2048 nt lds
  buffer_load_dwordx4 v196, s[28:31], s71 offen offset:3072 nt lds
  s_mov_b32 m0, s76
  s_add_u32 s71, s81, 4096
  buffer_load_dwordx4 v197, s[28:31], s71 offen offset:0 nt lds
  buffer_load_dwordx4 v198, s[28:31], s71 offen offset:1024 nt lds
  s_waitcnt vmcnt(6)
  s_mov_b32 m0, s76
  s_add_u32 s71, s81, 4096
  buffer_load_dwordx4 v196, s[28:31], s71 offen offset:2048 nt lds
  buffer_load_dwordx4 v197, s[28:31], s71 offen offset:3072 nt lds
  s_mov_b32 m0, s77
  s_add_u32 s71, s81, 8192
  buffer_load_dwordx4 v198, s[28:31], s71 offen offset:0 nt lds
  buffer_load_dwordx4 v196, s[28:31], s71 offen offset:1024 nt lds
  buffer_load_dwordx4 v197, s[28:31], s71 offen offset:2048 nt lds
  buffer_load_dwordx4 v198, s[28:31], s71 offen offset:3072 nt lds
  ds_read_b64_tr_b16 v[68:69], v204 offset:12288
  ds_read_b64_tr_b16 v[70:71], v204 offset:18432
  ds_read_b64_tr_b16 v[72:73], v205 offset:12288
  ds_read_b64_tr_b16 v[74:75], v205 offset:18432
  ds_read_b64_tr_b16 v[76:77], v206 offset:12288
  ds_read_b64_tr_b16 v[78:79], v206 offset:18432
  ds_read_b64_tr_b16 v[80:81], v207 offset:12288
  ds_read_b64_tr_b16 v[82:83], v207 offset:18432
  ds_read_b64_tr_b16 v[84:85], v204 offset:12416
  ds_read_b64_tr_b16 v[86:87], v204 offset:18560
  ds_read_b64_tr_b16 v[88:89], v205 offset:12416
  ds_read_b64_tr_b16 v[90:91], v205 offset:18560
  ds_read_b64_tr_b16 v[92:93], v206 offset:12416
  ds_read_b64_tr_b16 v[94:95], v206 offset:18560
  s_waitcnt lgkmcnt(12)
  v_mfma_f32_16x16x32_bf16 v[116:119], v[32:35], v[68:71], v[116:119]
  ds_read_b64_tr_b16 v[96:97], v207 offset:12416
  ds_read_b64_tr_b16 v[98:99], v207 offset:18560
  s_waitcnt lgkmcnt(12)
  v_mfma_f32_16x16x32_bf16 v[120:123], v[32:35], v[72:75], v[120:123]
  ds_read_b64_tr_b16 v[100:101], v204 offset:12544
  ds_read_b64_tr_b16 v[102:103], v204 offset:18688
  s_waitcnt lgkmcnt(12)
  v_mfma_f32_16x16x32_bf16 v[124:127], v[32:35], v[76:79], v[124:127]
  ds_read_b64_tr_b16 v[104:105], v205 offset:12544
  ds_read_b64_tr_b16 v[106:107], v205 offset:18688
  s_waitcnt lgkmcnt(12)
  v_mfma_f32_16x16x32_bf16 v[128:131], v[32:35], v[80:83], v[128:131]
  ds_read_b64_tr_b16 v[108:109], v206 offset:12544
  ds_read_b64_tr_b16 v[110:111], v206 offset:18688
  s_waitcnt lgkmcnt(12)
  v_mfma_f32_16x16x32_bf16 v[132:135], v[32:35], v[84:87], v[132:135]
  ds_read_b64_tr_b16 v[112:113], v207 offset:12544
  ds_read_b64_tr_b16 v[114:115], v207 offset:18688
  s_waitcnt lgkmcnt(12)
  v_mfma_f32_16x16x32_bf16 v[136:139], v[32:35], v[88:91], v[136:139]
  s_waitcnt lgkmcnt(10)
  v_mfma_f32_16x16x32_bf16 v[140:143], v[32:35], v[92:95], v[140:143]
  s_waitcnt lgkmcnt(8)
  v_mfma_f32_16x16x32_bf16 v[144:147], v[32:35], v[96:99], v[144:147]
  s_waitcnt lgkmcnt(6)
  v_mfma_f32_16x16x32_bf16 v[148:151], v[32:35], v[100:103], v[148:151]
  s_waitcnt lgkmcnt(4)
  v_mfma_f32_16x16x32_bf16 v[152:155], v[32:35], v[104:107], v[152:155]
  s_waitcnt lgkmcnt(2)
  v_mfma_f32_16x16x32_bf16 v[156:159], v[32:35], v[108:111], v[156:159]
  s_waitcnt lgkmcnt(0)
  v_mfma_f32_16x16x32_bf16 v[160:163], v[32:35], v[112:115], v[160:163]
  s_waitcnt vmcnt(6)
  s_mov_b32 m0, s78
  s_add_u32 s71, s81, 0
  buffer_load_dwordx4 v196, s[32:35], s71 offen offset:0 nt lds
  buffer_load_dwordx4 v197, s[32:35], s71 offen offset:1024 nt lds
  buffer_load_dwordx4 v198, s[32:35], s71 offen offset:2048 nt lds
  buffer_load_dwordx4 v196, s[32:35], s71 offen offset:3072 nt lds
  s_mov_b32 m0, s79
  s_add_u32 s71, s81, 4096
  buffer_load_dwordx4 v197, s[32:35], s71 offen offset:0 nt lds
  buffer_load_dwordx4 v198, s[32:35], s71 offen offset:1024 nt lds
  ds_read_b128 v[68:71], v200 offset:0
  ds_read_b128 v[72:75], v201 offset:0
  ds_read_b128 v[76:79], v200 offset:128
  ds_read_b128 v[80:83], v201 offset:128
  ds_read_b128 v[84:87], v200 offset:256
  ds_read_b128 v[88:91], v201 offset:256
  s_waitcnt lgkmcnt(5)
  v_mfma_f32_16x16x32_bf16 v[24:27], v[68:71], v[44:47], 0
  s_waitcnt lgkmcnt(4)
  v_mfma_f32_16x16x32_bf16 v[24:27], v[72:75], v[48:51], v[24:27]
  s_waitcnt lgkmcnt(3)
  v_mfma_f32_16x16x32_bf16 v[24:27], v[76:79], v[52:55], v[24:27]
  s_waitcnt lgkmcnt(2)
  v_mfma_f32_16x16x32_bf16 v[24:27], v[80:83], v[56:59], v[24:27]
  s_waitcnt lgkmcnt(1)
  v_mfma_f32_16x16x32_bf16 v[24:27], v[84:87], v[60:63], v[24:27]
  s_waitcnt lgkmcnt(0)
  v_mfma_f32_16x16x32_bf16 v[24:27], v[88:91], v[64:67], v[24:27]
  s_waitcnt vmcnt(6)
  s_mov_b32 m0, s79
  s_add_u32 s71, s81, 4096
  buffer_load_dwordx4 v196, s[32:35], s71 offen offset:2048 nt lds
  buffer_load_dwordx4 v197, s[32:35], s71 offen offset:3072 nt lds
  s_mov_b32 m0, s80
  s_add_u32 s71, s81, 8192
  buffer_load_dwordx4 v198, s[32:35], s71 offen offset:0 nt lds
  buffer_load_dwordx4 v196, s[32:35], s71 offen offset:1024 nt lds
  buffer_load_dwordx4 v197, s[32:35], s71 offen offset:2048 nt lds
  buffer_load_dwordx4 v198, s[32:35], s71 offen offset:3072 nt lds
  ds_read_b128 v[92:95], v200 offset:6144
  ds_read_b128 v[96:99], v201 offset:6144
  ds_read_b128 v[100:103], v200 offset:6272
  ds_read_b128 v[104:107], v201 offset:6272
  ds_read_b128 v[108:111], v200 offset:6400
  ds_read_b128 v[112:115], v201 offset:6400
  s_waitcnt lgkmcnt(5)
  v_mfma_f32_16x16x32_bf16 v[28:31], v[92:95], v[44:47], 0
  s_waitcnt lgkmcnt(4)
  v_mfma_f32_16x16x32_bf16 v[28:31], v[96:99], v[48:51], v[28:31]
  s_waitcnt lgkmcnt(3)
  v_mfma_f32_16x16x32_bf16 v[28:31], v[100:103], v[52:55], v[28:31]
  s_waitcnt lgkmcnt(2)
  v_mfma_f32_16x16x32_bf16 v[28:31], v[104:107], v[56:59], v[28:31]
  s_waitcnt lgkmcnt(1)
  v_mfma_f32_16x16x32_bf16 v[28:31], v[108:111], v[60:63], v[28:31]
  s_waitcnt lgkmcnt(0)
  v_mfma_f32_16x16x32_bf16 v[28:31], v[112:115], v[64:67], v[28:31]
  s_nop 6
  v_cvt_pk_bf16_f32 v32, v24, v25
  v_cvt_pk_bf16_f32 v33, v26, v27
  v_cvt_pk_bf16_f32 v34, v28, v29
  v_cvt_pk_bf16_f32 v35, v30, v31
  v_lshlrev_b32 v24, 16, v32
  v_and_b32 v25, 0xffff0000, v32
  v_lshlrev_b32 v26, 16, v33
  v_and_b32 v27, 0xffff0000, v33
  v_lshlrev_b32 v28, 16, v34
  v_and_b32 v29, 0xffff0000, v34
  v_lshlrev_b32 v30, 16, v35
  v_and_b32 v31, 0xffff0000, v35
  v_mul_f32 v24, s89, v24
  v_mul_f32 v25, s89, v25
  v_mul_f32 v26, s89, v26
  v_mul_f32 v27, s89, v27
  v_mul_f32 v28, s89, v28
  v_mul_f32 v29, s89, v29
  v_mul_f32 v30, s89, v30
  v_mul_f32 v31, s89, v31
  v_cvt_pk_bf16_f32 v32, v24, v25
  v_cvt_pk_bf16_f32 v33, v26, v27
  v_cvt_pk_bf16_f32 v34, v28, v29
  v_cvt_pk_bf16_f32 v35, v30, v31
  v_lshlrev_b32 v24, 16, v32
  v_and_b32 v25, 0xffff0000, v32
  v_lshlrev_b32 v26, 16, v33
  v_and_b32 v27, 0xffff0000, v33
  v_lshlrev_b32 v28, 16, v34
  v_and_b32 v29, 0xffff0000, v34
  v_lshlrev_b32 v30, 16, v35
  v_and_b32 v31, 0xffff0000, v35
  v_max3_f32 v6, v24, v25, v26
  v_max3_f32 v7, v27, v28, v29
  v_max3_f32 v6, v6, v30, v31
  v_max_f32 v6, v6, v7
  v_mov_b32 v7, v6
  s_nop 1
  v_permlane16_swap_b32 v6, v7
  v_max_f32 v6, v6, v7
  v_mov_b32 v7, v6
  s_nop 1
  v_permlane32_swap_b32 v6, v7
  v_max_f32 v6, v6, v7
  v_mul_f32 v6, s88, v6
  v_cmp_gt_f32 vcc, v6, v16
  s_nop 0
  s_cbranch_vccz L_keep3
  v_sub_f32 v7, v16, v6
  v_exp_f32 v7, v7
  v_mov_b32 v16, v6
  v_mul_f32 v17, v17, v7
  v_mul_f32 v116, v116, v7
  v_mul_f32 v120, v120, v7
  v_mul_f32 v124, v124, v7
  v_mul_f32 v128, v128, v7
  v_mul_f32 v132, v132, v7
  v_mul_f32 v136, v136, v7
  v_mul_f32 v140, v140, v7
  v_mul_f32 v144, v144, v7
  v_mul_f32 v148, v148, v7
  v_mul_f32 v152, v152, v7
  v_mul_f32 v156, v156, v7
  v_mul_f32 v160, v160, v7
L_keep3:
  v_fma_f32 v36, v24, s88, -v16
  v_fma_f32 v37, v25, s88, -v16
  v_fma_f32 v38, v26, s88, -v16
  v_fma_f32 v39, v27, s88, -v16
  v_fma_f32 v40, v28, s88, -v16
  v_fma_f32 v41, v29, s88, -v16
  v_fma_f32 v42, v30, s88, -v16
  v_fma_f32 v43, v31, s88, -v16
  v_exp_f32 v36, v36
  v_exp_f32 v37, v37
  v_exp_f32 v38, v38
  v_exp_f32 v39, v39
  v_exp_f32 v40, v40
  v_exp_f32 v41, v41
  v_exp_f32 v42, v42
  v_exp_f32 v43, v43
  s_nop 0
  v_cvt_pk_bf16_f32 v32, v36, v37
  v_cvt_pk_bf16_f32 v33, v38, v39
  v_cvt_pk_bf16_f32 v34, v40, v41
  v_cvt_pk_bf16_f32 v35, v42, v43
  v_add_f32 v36, v36, v40
  v_add_f32 v37, v37, v41
  v_add_f32 v38, v38, v42
  v_add_f32 v39, v39, v43
  v_add_f32 v36, v36, v37
  v_add_f32 v38, v38, v39
  v_add_f32 v36, v36, v38
  v_add_f32 v17, v17, v36
  s_branch L_loop
L_lastv:
  s_mul_i32 s71, s64, 1920
  s_add_u32 s71, s71, 512
  v_lshl_add_u32 v8, v23, 2, s71
  v_mov_b32 v7, s71
  v_mov_b32 v6, v17
  s_nop 1
  v_permlane16_swap_b32 v17, v6
  v_add_f32 v17, v17, v6
  v_mov_b32 v6, v17
  s_nop 1
  v_permlane32_swap_b32 v17, v6
  v_add_f32 v17, v17, v6
  s_bfm_b64 exec, 16, 0
  ds_write_b64 v7, v[16:17] offset:768
  s_mov_b64 exec, -1
  s_waitcnt vmcnt(0)
  ds_read_b64_tr_b16 v[68:69], v204 offset:12288
  ds_read_b64_tr_b16 v[70:71], v204 offset:18432
  ds_read_b64_tr_b16 v[72:73], v205 offset:12288
  ds_read_b64_tr_b16 v[74:75], v205 offset:18432
  ds_read_b64_tr_b16 v[76:77], v206 offset:12288
  ds_read_b64_tr_b16 v[78:79], v206 offset:18432
  ds_read_b64_tr_b16 v[80:81], v207 offset:12288
  ds_read_b64_tr_b16 v[82:83], v207 offset:18432
  ds_read_b64_tr_b16 v[84:85], v204 offset:12416
  ds_read_b64_tr_b16 v[86:87], v204 offset:18560
  ds_read_b64_tr_b16 v[88:89], v205 offset:12416
  ds_read_b64_tr_b16 v[90:91], v205 offset:18560
  ds_read_b64_tr_b16 v[92:93], v206 offset:12416
  ds_read_b64_tr_b16 v[94:95], v206 offset:18560
  s_waitcnt lgkmcnt(12)
  v_mfma_f32_16x16x32_bf16 v[116:119], v[32:35], v[68:71], v[116:119]
  ds_read_b64_tr_b16 v[96:97], v207 offset:12416
  ds_read_b64_tr_b16 v[98:99], v207 offset:18560
  s_waitcnt lgkmcnt(12)
  v_mfma_f32_16x16x32_bf16 v[120:123], v[32:35], v[72:75], v[120:123]
  ds_read_b64_tr_b16 v[100:101], v204 offset:12544
  ds_read_b64_tr_b16 v[102:103], v204 offset:18688
  s_waitcnt lgkmcnt(12)
  v_mfma_f32_16x16x32_bf16 v[124:127], v[32:35], v[76:79], v[124:127]
  ds_read_b64_tr_b16 v[104:105], v205 offset:12544
  ds_read_b64_tr_b16 v[106:107], v205 offset:18688
  s_waitcnt lgkmcnt(12)
  v_mfma_f32_16x16x32_bf16 v[128:131], v[32:35], v[80:83], v[128:131]
  ds_read_b64_tr_b16 v[108:109], v206 offset:12544
  ds_read_b64_tr_b16 v[110:111], v206 offset:18688
  s_waitcnt lgkmcnt(12)
  v_mfma_f32_16x16x32_bf16 v[132:135], v[32:35], v[84:87], v[132:135]
  ds_read_b64_tr_b16 v[112:113], v207 offset:12544
  ds_read_b64_tr_b16 v[114:115], v207 offset:18688
  s_waitcnt lgkmcnt(12)
  v_mfma_f32_16x16x32_bf16 v[136:139], v[32:35], v[88:91], v[136:139]
  s_waitcnt lgkmcnt(10)
  v_mfma_f32_16x16x32_bf16 v[140:143], v[32:35], v[92:95], v[140:143]
  s_waitcnt lgkmcnt(8)
  v_mfma_f32_16x16x32_bf16 v[144:147], v[32:35], v[96:99], v[144:147]
  s_waitcnt lgkmcnt(6)
  v_mfma_f32_16x16x32_bf16 v[148:151], v[32:35], v[100:103], v[148:151]
  s_waitcnt lgkmcnt(4)
  v_mfma_f32_16x16x32_bf16 v[152:155], v[32:35], v[104:107], v[152:155]
  s_waitcnt lgkmcnt(2)
  v_mfma_f32_16x16x32_bf16 v[156:159], v[32:35], v[108:111], v[156:159]
  s_waitcnt lgkmcnt(0)
  v_mfma_f32_16x16x32_bf16 v[160:163], v[32:35], v[112:115], v[160:163]
  s_bfm_b64 exec, 16, 0
  s_nop 1
  ds_write2_b32 v8, v116, v120 offset0:0 offset1:16
  ds_write2_b32 v8, v124, v128 offset0:32 offset1:48
  ds_write2_b32 v8, v132, v136 offset0:64 offset1:80
  ds_write2_b32 v8, v140, v144 offset0:96 offset1:112
  ds_write2_b32 v8, v148, v152 offset0:128 offset1:144
  ds_write2_b32 v8, v156, v160 offset0:160 offset1:176
  s_mov_b64 exec, -1
  v_mov_b32 v6, 0
  s_add_u32 s71, s68, 262144
  s_waitcnt lgkmcnt(0)
  s_barrier
  s_cmp_lg_u32 s64, 0
  s_cbranch_scc1 L_pub_done
  ds_read_b64 v[36:37], v6 offset:1280
  ds_read_b64 v[38:39], v6 offset:3200
  ds_read_b64 v[40:41], v6 offset:5120
  ds_read_b64 v[42:43], v6 offset:7040
  ds_read_b128 v[68:71], v2 offset:512
  ds_read_b128 v[72:75], v2 offset:2432
  ds_read_b128 v[76:79], v2 offset:4352
  ds_read_b128 v[80:83], v2 offset:6272
  s_waitcnt lgkmcnt(4)
  v_max3_f32 v6, v36, v38, v40
  v_max_f32 v6, v6, v42
  v_sub_f32 v36, v36, v6
  v_sub_f32 v38, v38, v6
  v_sub_f32 v40, v40, v6
  v_sub_f32 v42, v42, v6
  v_exp_f32 v36, v36
  v_exp_f32 v38, v38
  v_exp_f32 v40, v40
  v_exp_f32 v42, v42
  s_waitcnt lgkmcnt(0)
  v_mul_f32 v7, v36, v37
  v_pk_mul_f32 v[24:25], v[36:37], v[68:69] op_sel_hi:[0,1]
  v_pk_mul_f32 v[26:27], v[36:37], v[70:71] op_sel_hi:[0,1]
  v_fmac_f32 v7, v38, v39
  v_pk_fma_f32 v[24:25], v[38:39], v[72:73], v[24:25] op_sel_hi:[0,1,1]
  v_pk_fma_f32 v[26:27], v[38:39], v[74:75], v[26:27] op_sel_hi:[0,1,1]
  v_fmac_f32 v7, v40, v41
  v_pk_fma_f32 v[24:25], v[40:41], v[76:77], v[24:25] op_sel_hi:[0,1,1]
  v_pk_fma_f32 v[26:27], v[40:41], v[78:79], v[26:27] op_sel_hi:[0,1,1]
  v_fmac_f32 v7, v42, v43
  v_pk_fma_f32 v[24:25], v[42:43], v[80:81], v[24:25] op_sel_hi:[0,1,1]
  v_pk_fma_f32 v[26:27], v[42:43], v[82:83], v[26:27] op_sel_hi:[0,1,1]
  s_bfm_b64 exec, 1, 48
  v_mov_b32 v24, v6
  v_mov_b32 v25, v7
  s_bfm_b64 exec, 49, 0
  v_min_u32 v24, 0xfffffffe, v24
  buffer_store_dwordx4 v[24:27], v2, s[36:39], s71 offen sc1
  s_mov_b64 exec, -1
L_pub_done:
  s_barrier
  s_cmp_ge_u32 s67, 20
  s_cbranch_scc1 L_wf4
  s_mov_b32 s52, s12
  s_and_b32 s53, s13, 0xffff
  s_mov_b32 s54, 7864320
  s_mov_b32 s55, 0x20000
  v_mul_u32_u24 v7, 1280, v169
  v_lshl_add_u32 v7, v170, 1, v7
  s_lshl_b32 s71, s66, 2
  s_add_u32 s71, s71, s64
  s_mul_i32 s71, s71, 245760
  s_lshl_b32 s72, s67, 6
  s_add_u32 s71, s71, s72
  s_mul_i32 s73, s64, 12288
  s_add_u32 m0, s73, 22528
  s_add_u32 s72, s71, 184320
  buffer_load_dwordx4 v7, s[52:55], s72 offen nt lds
  s_add_u32 m0, s73, 23552
  s_add_u32 s72, s71, 204800
  buffer_load_dwordx4 v7, s[52:55], s72 offen nt lds
  s_add_u32 m0, s73, 24576
  s_add_u32 s72, s71, 225280
  buffer_load_dwordx4 v7, s[52:55], s72 offen nt lds
  s_branch L_wd5
L_wf4:
  s_mov_b32 s52, s16
  s_and_b32 s53, s17, 0xffff
  s_mov_b32 s54, 1966080
  s_mov_b32 s55, 0x20000
  s_mov_b32 s56, s18
  s_and_b32 s57, s19, 0xffff
  s_mov_b32 s58, 1966080
  s_mov_b32 s59, 0x20000
  v_lshrrev_b32 v7, 1, v1
  v_mul_u32_u24 v7, 3072, v7
  v_and_b32 v8, 1, v1
  v_lshl_add_u32 v7, v8, 4, v7
  s_mul_i32 s71, s64, 491520
  s_lshl_b32 s72, s70, 5
  s_add_u32 s71, s71, s72
  s_mul_i32 s73, s64, 5120
  s_add_u32 m0, s73, 16384
  s_add_u32 s72, s71, 294912
  buffer_load_dwordx4 v7, s[52:55], s72 offen nt lds
  s_add_u32 m0, s73, 17408
  s_add_u32 s72, s71, 393216
  buffer_load_dwordx4 v7, s[52:55], s72 offen nt lds
  s_mul_i32 s71, s70, 20480
  s_add_u32 s71, s71, s73
  s_add_u32 m0, s73, 33792
  s_add_u32 s72, s71, 0
  buffer_load_dwordx4 v2, s[56:59], s72 offen nt lds
  s_add_u32 m0, s73, 34816
  s_add_u32 s72, s71, 1024
  buffer_load_dwordx4 v2, s[56:59], s72 offen nt lds
  s_add_u32 m0, s73, 35840
  s_add_u32 s72, s71, 2048
  buffer_load_dwordx4 v2, s[56:59], s72 offen nt lds
  s_add_u32 m0, s73, 36864
  s_add_u32 s72, s71, 3072
  buffer_load_dwordx4 v2, s[56:59], s72 offen nt lds
  s_add_u32 m0, s73, 37888
  s_add_u32 s72, s71, 4096
  buffer_load_dwordx4 v2, s[56:59], s72 offen nt lds
L_wd5:
  s_cmp_ge_u32 s67, 20
  s_cbranch_scc1 L_ffn
  s_mul_i32 s71, s64, 12288
  s_add_u32 s71, s71, 13312
  v_lshl_add_u32 v15, v169, 6, v170
  v_add_u32 v15, s71, v15
  s_lshl_b32 s72, s66, 2
  s_add_u32 s72, s72, s64
  s_lshl_b32 s72, s72, 13
  s_add_u32 s72, s72, 262144
  s_add_u32 s73, s72, 4096
  v_mov_b32 v10, 768
  s_lshl_b32 s71, s64, 9
  s_add_u32 s71, s71, 8192
  v_lshl_add_u32 v12, v1, 3, s71
  v_lshl_add_u32 v13, v5, 3, s71
  s_lshl_b32 s71, s64, 7
  s_add_u32 s71, s71, 10240
  v_lshl_add_u32 v14, v5, 4, s71
  s_mul_i32 s71, s66, 2560
  s_lshl_b32 s74, s67, 7
  s_add_u32 s71, s71, s74
  s_add_u32 s71, s71, 524288
  ds_read_b64_tr_b16 v[116:117], v15 offset:0
  ds_read_b64_tr_b16 v[118:119], v15 offset:1024
  ds_read_b64_tr_b16 v[120:121], v15 offset:2048
  ds_read_b64_tr_b16 v[122:123], v15 offset:3072
  ds_read_b64_tr_b16 v[124:125], v15 offset:4096
  ds_read_b64_tr_b16 v[126:127], v15 offset:5120
  ds_read_b64_tr_b16 v[128:129], v15 offset:6144
  ds_read_b64_tr_b16 v[130:131], v15 offset:7168
  ds_read_b64_tr_b16 v[132:133], v15 offset:8192
  s_waitcnt lgkmcnt(0)
  ds_read_b64_tr_b16 v[140:141], v15 offset:32
  ds_read_b64_tr_b16 v[142:143], v15 offset:1056
  ds_read_b64_tr_b16 v[144:145], v15 offset:2080
  ds_read_b64_tr_b16 v[146:147], v15 offset:3104
  ds_read_b64_tr_b16 v[148:149], v15 offset:4128
  ds_read_b64_tr_b16 v[150:151], v15 offset:5152
  ds_read_b64_tr_b16 v[152:153], v15 offset:6176
  ds_read_b64_tr_b16 v[154:155], v15 offset:7200
  ds_read_b64_tr_b16 v[156:157], v15 offset:8224
  s_waitcnt lgkmcnt(0)
  s_bfm_b64 exec, 48, 0
  s_mov_b32 s83, 65536
L_poll6:
  buffer_load_dwordx2 v[100:101], v10, s[36:39], s72 offen offset:0 sc1
  buffer_load_dwordx4 v[68:71], v2, s[36:39], s72 offen offset:0 sc1
  buffer_load_dwordx2 v[102:103], v10, s[36:39], s72 offen offset:1024 sc1
  buffer_load_dwordx4 v[72:75], v2, s[36:39], s72 offen offset:1024 sc1
  buffer_load_dwordx2 v[104:105], v10, s[36:39], s72 offen offset:2048 sc1
  buffer_load_dwordx4 v[76:79], v2, s[36:39], s72 offen offset:2048 sc1
  buffer_load_dwordx2 v[106:107], v10, s[36:39], s72 offen offset:3072 sc1
  buffer_load_dwordx4 v[80:83], v2, s[36:39], s72 offen offset:3072 sc1
  buffer_load_dwordx2 v[108:109], v10, s[36:39], s73 offen offset:0 sc1
  buffer_load_dwordx4 v[84:87], v2, s[36:39], s73 offen offset:0 sc1
  buffer_load_dwordx2 v[110:111], v10, s[36:39], s73 offen offset:1024 sc1
  buffer_load_dwordx4 v[88:91], v2, s[36:39], s73 offen offset:1024 sc1
  buffer_load_dwordx2 v[112:113], v10, s[36:39], s73 offen offset:2048 sc1
  buffer_load_dwordx4 v[92:95], v2, s[36:39], s73 offen offset:2048 sc1
  buffer_load_dwordx2 v[114:115], v10, s[36:39], s73 offen offset:3072 sc1
  buffer_load_dwordx4 v[96:99], v2, s[36:39], s73 offen offset:3072 sc1
  s_sub_u32 s83, s83, 1
  s_cbranch_scc1 L_end
  s_waitcnt vmcnt(0)
  v_max3_u32 v11, v68, v72, v76
  v_max3_u32 v11, v11, v80, v84
  v_max3_u32 v11, v11, v88, v92
  v_max3_u32 v11, v11, v96, v100
  v_max3_u32 v11, v11, v102, v104
  v_max3_u32 v11, v11, v106, v108
  v_max3_u32 v11, v11, v110, v112
  v_max_u32 v11, v11, v114
  v_cmp_eq_u32 vcc, -1, v11
  s_nop 0
  s_cbranch_vccnz L_poll6
L_got7:
  s_mov_b64 exec, -1
  ds_read_b64_tr_b16 v[134:135], v15 offset:9216
  ds_read_b64_tr_b16 v[136:137], v15 offset:10240
  ds_read_b64_tr_b16 v[138:139], v15 offset:11264
  ds_read_b64_tr_b16 v[158:159], v15 offset:9248
  ds_read_b64_tr_b16 v[160:161], v15 offset:10272
  ds_read_b64_tr_b16 v[162:163], v15 offset:11296
  s_bfm_b64 exec, 48, 0
  v_max3_f32 v6, v100, v102, v104
  v_max3_f32 v7, v106, v108, v110
  v_max3_f32 v6, v6, v112, v114
  v_max_f32 v6, v6, v7
  v_sub_f32 v100, v100, v6
  v_sub_f32 v102, v102, v6
  v_sub_f32 v104, v104, v6
  v_sub_f32 v106, v106, v6
  v_sub_f32 v108, v108, v6
  v_sub_f32 v110, v110, v6
  v_sub_f32 v112, v112, v6
  v_sub_f32 v114, v114, v6
  v_exp_f32 v100, v100
  v_exp_f32 v102, v102
  v_exp_f32 v104, v104
  v_exp_f32 v106, v106
  v_exp_f32 v108, v108
  v_exp_f32 v110, v110
  v_exp_f32 v112, v112
  v_exp_f32 v114, v114
  v_mul_f32 v8, v100, v101
  v_fmac_f32 v8, v102, v103
  v_fmac_f32 v8, v104, v105
  v_fmac_f32 v8, v106, v107
  v_fmac_f32 v8, v108, v109
  v_fmac_f32 v8, v110, v111
  v_fmac_f32 v8, v112, v113
  v_fmac_f32 v8, v114, v115
  v_rcp_f32 v8, v8
  v_pk_mul_f32 v[24:25], v[100:101], v[68:69] op_sel_hi:[0,1]
  v_pk_mul_f32 v[26:27], v[100:101], v[70:71] op_sel_hi:[0,1]
  v_pk_fma_f32 v[24:25], v[102:103], v[72:73], v[24:25] op_sel_hi:[0,1,1]
  v_pk_fma_f32 v[26:27], v[102:103], v[74:75], v[26:27] op_sel_hi:[0,1,1]
  v_pk_fma_f32 v[24:25], v[104:105], v[76:77], v[24:25] op_sel_hi:[0,1,1]
  v_pk_fma_f32 v[26:27], v[104:105], v[78:79], v[26:27] op_sel_hi:[0,1,1]
  v_pk_fma_f32 v[24:25], v[106:107], v[80:81], v[24:25] op_sel_hi:[0,1,1]
  v_pk_fma_f32 v[26:27], v[106:107], v[82:83], v[26:27] op_sel_hi:[0,1,1]
  v_pk_fma_f32 v[24:25], v[108:109], v[84:85], v[24:25] op_sel_hi:[0,1,1]
  v_pk_fma_f32 v[26:27], v[108:109], v[86:87], v[26:27] op_sel_hi:[0,1,1]
  v_pk_fma_f32 v[24:25], v[110:111], v[88:89], v[24:25] op_sel_hi:[0,1,1]
  v_pk_fma_f32 v[26:27], v[110:111], v[90:91], v[26:27] op_sel_hi:[0,1,1]
  v_pk_fma_f32 v[24:25], v[112:113], v[92:93], v[24:25] op_sel_hi:[0,1,1]
  v_pk_fma_f32 v[26:27], v[112:113], v[94:95], v[26:27] op_sel_hi:[0,1,1]
  v_pk_fma_f32 v[24:25], v[114:115], v[96:97], v[24:25] op_sel_hi:[0,1,1]
  v_pk_fma_f32 v[26:27], v[114:115], v[98:99], v[26:27] op_sel_hi:[0,1,1]
  v_pk_mul_f32 v[24:25], v[8:9], v[24:25] op_sel_hi:[0,1]
  v_pk_mul_f32 v[26:27], v[8:9], v[26:27] op_sel_hi:[0,1]
  v_cvt_pk_bf16_f32 v24, v24, v25
  v_cvt_pk_bf16_f32 v25, v26, v27
  ds_write_b64 v12, v[24:25]
  s_mov_b64 exec, -1
  s_waitcnt lgkmcnt(0)
  ds_read_b64 v[44:45], v13 offset:0
  ds_read_b64 v[46:47], v13 offset:32
  ds_read_b64 v[48:49], v13 offset:64
  ds_read_b64 v[50:51], v13 offset:96
  ds_read_b64 v[52:53], v13 offset:128
  ds_read_b64 v[54:55], v13 offset:160
  ds_read_b64 v[56:57], v13 offset:192
  ds_read_b64 v[58:59], v13 offset:224
  ds_read_b64 v[60:61], v13 offset:256
  ds_read_b64 v[62:63], v13 offset:288
  ds_read_b64 v[64:65], v13 offset:320
  ds_read_b64 v[66:67], v13 offset:352
  s_waitcnt lgkmcnt(10)
  v_mfma_f32_16x16x32_bf16 v[24:27], v[116:119], v[44:47], 0
  v_mfma_f32_16x16x32_bf16 v[28:31], v[140:143], v[44:47], 0
  s_waitcnt lgkmcnt(8)
  v_mfma_f32_16x16x32_bf16 v[24:27], v[120:123], v[48:51], v[24:27]
  v_mfma_f32_16x16x32_bf16 v[28:31], v[144:147], v[48:51], v[28:31]
  s_waitcnt lgkmcnt(6)
  v_mfma_f32_16x16x32_bf16 v[24:27], v[124:127], v[52:55], v[24:27]
  v_mfma_f32_16x16x32_bf16 v[28:31], v[148:151], v[52:55], v[28:31]
  s_waitcnt lgkmcnt(4)
  v_mfma_f32_16x16x32_bf16 v[24:27], v[128:131], v[56:59], v[24:27]
  v_mfma_f32_16x16x32_bf16 v[28:31], v[152:155], v[56:59], v[28:31]
  s_waitcnt lgkmcnt(2)
  v_mfma_f32_16x16x32_bf16 v[24:27], v[132:135], v[60:63], v[24:27]
  v_mfma_f32_16x16x32_bf16 v[28:31], v[156:159], v[60:63], v[28:31]
  s_waitcnt lgkmcnt(0)
  v_mfma_f32_16x16x32_bf16 v[24:27], v[136:139], v[64:67], v[24:27]
  v_mfma_f32_16x16x32_bf16 v[28:31], v[160:163], v[64:67], v[28:31]
  s_mov_b32 exec_lo, 0x00010001
  s_mov_b32 exec_hi, 0x00010001
  s_nop 4
  ds_write_b128 v14, v[24:27] offset:0
  ds_write_b128 v14, v[28:31] offset:64
  s_bfm_b64 exec, 8, 0
  s_waitcnt lgkmcnt(0)
  s_barrier
  s_cmp_lg_u32 s64, 0
  s_cbranch_scc1 L_fin
  ds_read_b128 v[68:71], v2 offset:10240
  ds_read_b128 v[72:75], v2 offset:10368
  ds_read_b128 v[76:79], v2 offset:10496
  ds_read_b128 v[80:83], v2 offset:10624
  s_waitcnt lgkmcnt(0)
  v_pk_add_f32 v[68:69], v[68:69], v[72:73]
  v_pk_add_f32 v[76:77], v[76:77], v[80:81]
  v_pk_add_f32 v[70:71], v[70:71], v[74:75]
  v_pk_add_f32 v[78:79], v[78:79], v[82:83]
  v_pk_add_f32 v[68:69], v[68:69], v[76:77]
  v_pk_add_f32 v[70:71], v[70:71], v[78:79]
  v_min_u32 v68, 0xfffffffe, v68
  buffer_store_dwordx4 v[68:71], v2, s[36:39], s71 offen sc1
  s_branch L_fin
L_ffn:
  s_mul_i32 s71, s64, 5120
  s_add_u32 s71, s71, 13312
  v_lshl_add_u32 v6, v1, 3, s71
  v_cmp_eq_u32 vcc, 0, v23
  s_nop 1
  v_cndmask_b32 v182, 0, -1, vcc
  v_cmp_eq_u32 vcc, 1, v23
  s_nop 1
  v_cndmask_b32 v183, 0, -1, vcc
  v_cmp_eq_u32 vcc, 2, v23
  s_nop 1
  v_cndmask_b32 v184, 0, -1, vcc
  v_cmp_eq_u32 vcc, 3, v23
  s_nop 1
  v_cndmask_b32 v185, 0, -1, vcc
  v_cmp_eq_u32 vcc, 4, v23
  s_nop 1
  v_cndmask_b32 v186, 0, -1, vcc
  v_cmp_eq_u32 vcc, 5, v23
  s_nop 1
  v_cndmask_b32 v187, 0, -1, vcc
  v_cmp_eq_u32 vcc, 6, v23
  s_nop 1
  v_cndmask_b32 v188, 0, -1, vcc
  v_cmp_eq_u32 vcc, 7, v23
  s_nop 1
  v_cndmask_b32 v189, 0, -1, vcc
  v_cmp_eq_u32 vcc, 8, v23
  s_nop 1
  v_cndmask_b32 v190, 0, -1, vcc
  v_cmp_eq_u32 vcc, 9, v23
  s_nop 1
  v_cndmask_b32 v191, 0, -1, vcc
  s_waitcnt vmcnt(0)
  ds_read_b64_tr_b16 v[116:117], v6 offset:0
  ds_read_b64_tr_b16 v[118:119], v6 offset:512
  ds_read_b64_tr_b16 v[120:121], v6 offset:1024
  ds_read_b64_tr_b16 v[122:123], v6 offset:1536
  ds_read_b64_tr_b16 v[124:125], v6 offset:2048
  ds_read_b64_tr_b16 v[126:127], v6 offset:2560
  ds_read_b64_tr_b16 v[128:129], v6 offset:3072
  ds_read_b64_tr_b16 v[130:131], v6 offset:3584
  ds_read_b64_tr_b16 v[132:133], v6 offset:4096
  ds_read_b64_tr_b16 v[134:135], v6 offset:4608
  v_mul_u32_u24 v7, 1280, v169
  s_mul_i32 s71, s64, 320
  s_add_u32 s72, s71, 33792
  v_add3_u32 v7, v7, v170, s72
  v_mov_b32 v36, 0x3f803f80
  v_mov_b32 v37, 0x3f803f80
  v_mov_b32 v38, 0x3f803f80
  v_mov_b32 v39, 0x3f803f80
  v_lshlrev_b32 v12, 4, v5
  s_lshl_b32 s73, s64, 6
  v_add_u32 v13, s73, v12
  s_waitcnt lgkmcnt(0)
  v_mfma_f32_16x16x32_bf16 v[24:27], v[116:119], v[36:39], 0
  v_mfma_f32_16x16x32_bf16 v[24:27], v[120:123], v[36:39], v[24:27]
  v_mfma_f32_16x16x32_bf16 v[24:27], v[124:127], v[36:39], v[24:27]
  v_mfma_f32_16x16x32_bf16 v[24:27], v[128:131], v[36:39], v[24:27]
  v_mfma_f32_16x16x32_bf16 v[24:27], v[132:135], v[36:39], v[24:27]
  s_nop 7
  s_mov_b32 exec_lo, 0x00010001
  s_mov_b32 exec_hi, 0x00010001
  ds_write_b128 v13, v[24:27] offset:12352
  s_mov_b64 exec, -1
  s_waitcnt lgkmcnt(0)
  s_barrier
  ds_read_b128 v[68:71], v12 offset:12352
  ds_read_b128 v[72:75], v12 offset:12416
  ds_read_b128 v[76:79], v12 offset:12480
  ds_read_b128 v[80:83], v12 offset:12544
  ds_read_b64_tr_b16 v[136:137], v7 offset:0
  ds_read_b64_tr_b16 v[138:139], v7 offset:32
  ds_read_b64_tr_b16 v[140:141], v7 offset:64
  ds_read_b64_tr_b16 v[142:143], v7 offset:96
  ds_read_b64_tr_b16 v[144:145], v7 offset:128
  ds_read_b64_tr_b16 v[146:147], v7 offset:160
  ds_read_b64_tr_b16 v[148:149], v7 offset:192
  ds_read_b64_tr_b16 v[150:151], v7 offset:224
  ds_read_b64_tr_b16 v[152:153], v7 offset:256
  ds_read_b64_tr_b16 v[154:155], v7 offset:288
  v_lshlrev_b32 v160, 16, v20
  v_and_b32 v161, 0xffff0000, v20
  v_lshlrev_b32 v162, 16, v21
  v_and_b32 v163, 0xffff0000, v21
  v_lshl_add_u32 v10, v1, 3, s71
  v_lshl_add_u32 v11, v5, 3, s71
  s_lshl_b32 s73, s64, 3
  v_mov_b32 v14, s73
  v_lshl_add_u32 v15, v23, 6, v12
  s_waitcnt lgkmcnt(0)
  v_pk_add_f32 v[68:69], v[68:69], v[72:73]
  v_pk_add_f32 v[76:77], v[76:77], v[80:81]
  v_pk_add_f32 v[70:71], v[70:71], v[74:75]
  v_pk_add_f32 v[78:79], v[78:79], v[82:83]
  v_pk_add_f32 v[68:69], v[68:69], v[76:77]
  v_pk_add_f32 v[70:71], v[70:71], v[78:79]
  v_mov_b32 v156, v68
  v_mov_b32 v157, v69
  v_mov_b32 v158, v70
  v_mov_b32 v159, v71
  s_mul_i32 s72, s64, 640
  s_mul_i32 s71, s70, 2560
  s_add_u32 s71, s71, s72
  s_add_u32 s71, s71, 589824
  s_add_u32 s72, s72, 524288
  s_add_u32 s73, s72, 5120
  s_add_u32 s74, s72, 10240
  s_add_u32 s86, s72, 15360
  v_mov_b32 v28, 0
  v_mov_b32 v29, 0
  s_bfm_b64 exec, 40, 0
  s_mov_b32 s83, 65536
L_poll8:
  buffer_load_dwordx4 v[68:71], v2, s[36:39], s72 offen offset:0 sc1
  buffer_load_dwordx4 v[72:75], v2, s[36:39], s72 offen offset:2560 sc1
  buffer_load_dwordx4 v[76:79], v2, s[36:39], s73 offen offset:0 sc1
  buffer_load_dwordx4 v[80:83], v2, s[36:39], s73 offen offset:2560 sc1
  buffer_load_dwordx4 v[84:87], v2, s[36:39], s74 offen offset:0 sc1
  buffer_load_dwordx4 v[88:91], v2, s[36:39], s74 offen offset:2560 sc1
  buffer_load_dwordx4 v[92:95], v2, s[36:39], s86 offen offset:0 sc1
  buffer_load_dwordx4 v[96:99], v2, s[36:39], s86 offen offset:2560 sc1
  s_sub_u32 s83, s83, 1
  s_cbranch_scc1 L_end
  s_waitcnt vmcnt(0)
  v_max3_u32 v9, v68, v72, v76
  v_max3_u32 v9, v9, v80, v84
  v_max3_u32 v9, v9, v88, v92
  v_max_u32 v9, v9, v96
  v_cmp_eq_u32 vcc, -1, v9
  s_nop 0
  s_cbranch_vccnz L_poll8
L_got9:
  v_pk_add_f32 v[68:69], v[68:69], v[72:73]
  v_pk_add_f32 v[76:77], v[76:77], v[80:81]
  v_pk_add_f32 v[70:71], v[70:71], v[74:75]
  v_pk_add_f32 v[78:79], v[78:79], v[82:83]
  v_pk_add_f32 v[68:69], v[68:69], v[76:77]
  v_pk_add_f32 v[70:71], v[70:71], v[78:79]
  v_pk_add_f32 v[84:85], v[84:85], v[88:89]
  v_pk_add_f32 v[92:93], v[92:93], v[96:97]
  v_pk_add_f32 v[86:87], v[86:87], v[90:91]
  v_pk_add_f32 v[94:95], v[94:95], v[98:99]
  v_pk_add_f32 v[84:85], v[84:85], v[92:93]
  v_pk_add_f32 v[86:87], v[86:87], v[94:95]
  v_pk_add_f32 v[68:69], v[68:69], v[84:85]
  v_pk_add_f32 v[70:71], v[70:71], v[86:87]
  v_cvt_pk_bf16_f32 v72, v68, v69
  v_cvt_pk_bf16_f32 v73, v70, v71
  v_lshlrev_b32 v68, 16, v72
  v_and_b32 v69, 0xffff0000, v72
  v_lshlrev_b32 v70, 16, v73
  v_and_b32 v71, 0xffff0000, v73
  v_pk_add_f32 v[68:69], v[68:69], v[160:161]
  v_pk_add_f32 v[70:71], v[70:71], v[162:163]
  v_cvt_pk_bf16_f32 v32, v68, v69
  v_cvt_pk_bf16_f32 v33, v70, v71
  ds_write_b64 v10, v[32:33] offset:10752
  v_lshlrev_b32 v68, 16, v32
  v_and_b32 v69, 0xffff0000, v32
  v_lshlrev_b32 v70, 16, v33
  v_and_b32 v71, 0xffff0000, v33
  v_pk_add_f32 v[72:73], v[68:69], v[70:71]
  v_pk_mul_f32 v[68:69], v[68:69], v[68:69]
  v_pk_fma_f32 v[68:69], v[70:71], v[70:71], v[68:69]
  v_add_f32 v28, v72, v73
  v_add_f32 v29, v68, v69
  s_mov_b64 exec, -1
  s_waitcnt lgkmcnt(0)
  ds_read_b64 v[44:45], v11 offset:10752
  ds_read_b64 v[46:47], v11 offset:10784
  ds_read_b64 v[48:49], v11 offset:10816
  ds_read_b64 v[50:51], v11 offset:10848
  ds_read_b64 v[52:53], v11 offset:10880
  ds_read_b64 v[54:55], v11 offset:10912
  ds_read_b64 v[56:57], v11 offset:10944
  ds_read_b64 v[58:59], v11 offset:10976
  ds_read_b64 v[60:61], v11 offset:11008
  ds_read_b64 v[62:63], v11 offset:11040
  v_add_f32_dpp v28, v28, v28 row_ror:8 row_mask:0xf bank_mask:0xf
  v_add_f32_dpp v29, v29, v29 row_ror:8 row_mask:0xf bank_mask:0xf
  s_waitcnt lgkmcnt(8)
  v_mfma_f32_16x16x32_bf16 v[24:27], v[116:119], v[44:47], 0
  v_add_f32_dpp v28, v28, v28 row_ror:4 row_mask:0xf bank_mask:0xf
  v_add_f32_dpp v29, v29, v29 row_ror:4 row_mask:0xf bank_mask:0xf
  s_waitcnt lgkmcnt(6)
  v_mfma_f32_16x16x32_bf16 v[24:27], v[120:123], v[48:51], v[24:27]
  v_add_f32_dpp v28, v28, v28 row_ror:2 row_mask:0xf bank_mask:0xf
  v_add_f32_dpp v29, v29, v29 row_ror:2 row_mask:0xf bank_mask:0xf
  s_waitcnt lgkmcnt(4)
  v_mfma_f32_16x16x32_bf16 v[24:27], v[124:127], v[52:55], v[24:27]
  v_add_f32_dpp v28, v28, v28 row_ror:1 row_mask:0xf bank_mask:0xf
  v_add_f32_dpp v29, v29, v29 row_ror:1 row_mask:0xf bank_mask:0xf
  s_waitcnt lgkmcnt(2)
  v_mfma_f32_16x16x32_bf16 v[24:27], v[128:131], v[56:59], v[24:27]
  s_waitcnt lgkmcnt(0)
  v_mfma_f32_16x16x32_bf16 v[24:27], v[132:135], v[60:63], v[24:27]
  v_permlane32_swap_b32 v28, v29
  v_add_f32 v28, v28, v29
  v_mov_b32 v29, v28
  v_lshrrev_b32 v9, 5, v1
  v_lshl_add_u32 v9, v9, 2, v14
  v_permlane16_swap_b32 v28, v29
  v_add_f32 v28, v28, v29
  s_mov_b32 exec_lo, 0x00010001
  s_mov_b32 exec_hi, 0x00010001
  ds_write_b32 v9, v28 offset:12032
  ds_write_b128 v13, v[24:27] offset:12096
  s_mov_b64 exec, -1
  v_mov_b32 v6, 0
  s_waitcnt lgkmcnt(0)
  s_barrier
  ds_read_b128 v[36:39], v6 offset:12032
  ds_read_b128 v[40:43], v6 offset:12048
  ds_read_b128 v[68:71], v12 offset:12096
  ds_read_b128 v[72:75], v12 offset:12160
  ds_read_b128 v[76:79], v12 offset:12224
  ds_read_b128 v[80:83], v12 offset:12288
  s_waitcnt lgkmcnt(4)
  v_pk_add_f32 v[36:37], v[36:37], v[38:39]
  v_pk_add_f32 v[40:41], v[40:41], v[42:43]
  v_pk_add_f32 v[36:37], v[36:37], v[40:41]
  v_mul_f32 v6, 0x3acccccd, v36
  v_mul_f32 v7, 0x3acccccd, v37
  v_fma_f32 v7, -v6, v6, v7
  v_max_f32 v7, 0, v7
  v_cvt_pk_bf16_f32 v9, v6, v7
  v_lshlrev_b32 v6, 16, v9
  v_and_b32 v7, 0xffff0000, v9
  v_add_f32 v7, 0x3727c5ac, v7
  v_cvt_pk_bf16_f32 v9, v7, v7
  v_and_b32 v7, 0xffff0000, v9
  v_sqrt_f32 v7, v7
  s_waitcnt lgkmcnt(0)
  v_pk_add_f32 v[68:69], v[68:69], v[72:73]
  v_pk_add_f32 v[76:77], v[76:77], v[80:81]
  v_pk_add_f32 v[70:71], v[70:71], v[74:75]
  v_pk_add_f32 v[78:79], v[78:79], v[82:83]
  v_pk_add_f32 v[68:69], v[68:69], v[76:77]
  v_pk_add_f32 v[70:71], v[70:71], v[78:79]
  v_cvt_pk_bf16_f32 v9, v7, v7
  v_and_b32 v7, 0xffff0000, v9
  v_rcp_f32 v8, v7
  v_pk_fma_f32 v[68:69], v[6:7], v[156:157], v[68:69] op_sel_hi:[0,1,1] neg_lo:[1,0,0] neg_hi:[1,0,0]
  v_pk_fma_f32 v[70:71], v[6:7], v[158:159], v[70:71] op_sel_hi:[0,1,1] neg_lo:[1,0,0] neg_hi:[1,0,0]
  v_pk_mul_f32 v[68:69], v[8:9], v[68:69] op_sel_hi:[0,1]
  v_pk_mul_f32 v[70:71], v[8:9], v[70:71] op_sel_hi:[0,1]
  v_max_f32 v68, 0, v68
  v_max_f32 v69, 0, v69
  v_max_f32 v70, 0, v70
  v_max_f32 v71, 0, v71
  v_cvt_pk_bf16_f32 v72, v68, v69
  v_cvt_pk_bf16_f32 v73, v70, v71
  v_and_b32 v44, v72, v182
  v_and_b32 v45, v73, v182
  v_and_b32 v46, v72, v183
  v_and_b32 v47, v73, v183
  v_and_b32 v48, v72, v184
  v_and_b32 v49, v73, v184
  v_and_b32 v50, v72, v185
  v_and_b32 v51, v73, v185
  v_mfma_f32_16x16x32_bf16 v[24:27], v[136:139], v[44:47], 0
  v_and_b32 v52, v72, v186
  v_and_b32 v53, v73, v186
  v_and_b32 v54, v72, v187
  v_and_b32 v55, v73, v187
  v_mfma_f32_16x16x32_bf16 v[24:27], v[140:143], v[48:51], v[24:27]
  v_and_b32 v56, v72, v188
  v_and_b32 v57, v73, v188
  v_and_b32 v58, v72, v189
  v_and_b32 v59, v73, v189
  v_mfma_f32_16x16x32_bf16 v[24:27], v[144:147], v[52:55], v[24:27]
  v_and_b32 v60, v72, v190
  v_and_b32 v61, v73, v190
  v_and_b32 v62, v72, v191
  v_and_b32 v63, v73, v191
  v_mfma_f32_16x16x32_bf16 v[24:27], v[148:151], v[56:59], v[24:27]
  s_nop 0
  v_mfma_f32_16x16x32_bf16 v[24:27], v[152:155], v[60:63], v[24:27]
  s_mov_b32 exec_lo, 0x03ff03ff
  s_mov_b32 exec_hi, 0x03ff03ff
  s_nop 5
  v_min_u32 v24, 0xfffffffe, v24
  buffer_store_dwordx4 v[24:27], v15, s[36:39], s71 offen sc1
  s_mov_b64 exec, -1
  s_cmp_ge_u32 s67, 23
  s_cbranch_scc1 L_fin
  s_mul_i32 s70, s66, 3
  s_add_u32 s70, s70, s67
  s_sub_u32 s70, s70, 20
  s_cmp_ge_u32 s70, 20
  s_cbranch_scc1 L_fin
  v_lshrrev_b32 v6, 3, v1
  v_mul_u32_u24 v6, 2560, v6
  v_and_b32 v7, 7, v1
  v_lshl_add_u32 v6, v7, 4, v6
  s_mul_i32 s72, s64, 61440
  s_lshl_b32 s73, s70, 7
  s_add_u32 s72, s72, s73
  s_add_u32 s72, s72, 589824
  s_add_u32 s73, s72, 20480
  s_add_u32 s74, s72, 40960
  s_mov_b32 s60, s20
  s_and_b32 s61, s21, 0xffff
  s_mov_b32 s62, 1280
  s_mov_b32 s63, 0x20000
  v_lshrrev_b32 v8, 1, v5
  v_and_b32 v9, 1, v5
  v_lshl_add_u32 v8, v9, 1, v8
  v_lshl_add_u32 v8, v7, 2, v8
  s_lshl_b32 s71, s64, 7
  v_lshl_add_u32 v8, v8, 2, s71
  v_lshlrev_b32 v9, 2, v1
  s_lshl_b32 s71, s70, 6
  v_lshl_add_u32 v10, v1, 1, s71
  ds_read_u16 v36, v10 offset:10752
  s_mov_b32 s83, 65536
L_poll10:
  buffer_load_dwordx4 v[68:71], v6, s[36:39], s72 offen sc1
  buffer_load_dwordx4 v[72:75], v6, s[36:39], s73 offen sc1
  buffer_load_dwordx4 v[76:79], v6, s[36:39], s74 offen sc1
  s_sub_u32 s83, s83, 1
  s_cbranch_scc1 L_end
  s_waitcnt vmcnt(0)
  v_max3_u32 v11, v68, v72, v76
  v_cmp_eq_u32 vcc, -1, v11
  s_nop 0
  s_cbranch_vccnz L_poll10
L_got11:
  v_pk_add_f32 v[68:69], v[68:69], v[72:73]
  v_pk_add_f32 v[70:71], v[70:71], v[74:75]
  v_pk_add_f32 v[68:69], v[68:69], v[76:77]
  v_pk_add_f32 v[70:71], v[70:71], v[78:79]
  s_nop 0
  v_permlane32_swap_b32 v68, v69
  v_permlane32_swap_b32 v70, v71
  v_add_f32 v68, v68, v69
  v_add_f32 v70, v70, v71
  s_nop 1
  v_permlane16_swap_b32 v68, v70
  v_add_f32 v68, v68, v70
  s_nop 1
  v_add_f32_dpp v68, v68, v68 row_ror:8 row_mask:0xf bank_mask:0xf
  ds_write_b32 v8, v68 offset:12608
  s_bfm_b64 exec, 32, 0
  s_waitcnt lgkmcnt(0)
  s_barrier
  s_cmp_lg_u32 s64, 0
  s_cbranch_scc1 L_fin
  ds_read_b32 v68, v9 offset:12608
  ds_read_b32 v69, v9 offset:12736
  ds_read_b32 v70, v9 offset:12864
  ds_read_b32 v71, v9 offset:12992
  v_lshlrev_b32 v36, 16, v36
  s_waitcnt lgkmcnt(0)
  v_pk_add_f32 v[68:69], v[68:69], v[70:71]
  v_add_f32 v68, v68, v69
  v_cvt_pk_bf16_f32 v69, v68, v68
  v_and_b32 v68, 0xffff0000, v69
  v_add_f32 v68, v68, v36
  v_cvt_pk_bf16_f32 v68, v68, v68
  buffer_store_short v68, v10, s[60:63], 0 offen
  s_mov_b64 exec, -1
L_fin:
L_end:
  s_endpgm
.section .rodata,"a"
.p2align 6
.amdhsa_kernel sequential_preLN__mha_block_cached__dense_activation_relu__decode_kernel
  .amdhsa_next_free_vgpr 216
  .amdhsa_next_free_sgpr 102
  .amdhsa_accum_offset 216
  .amdhsa_group_segment_fixed_size 0
  .amdhsa_kernarg_size 88
  .amdhsa_user_sgpr_count 2
  .amdhsa_user_sgpr_kernarg_segment_ptr 1
  .amdhsa_system_sgpr_workgroup_id_x 1
  .amdhsa_float_denorm_mode_32 3
.end_amdhsa_kernel
```
